```python
import torch

def _softmax(x, axis=-1):
    return torch.softmax(x, dim=axis)
def _gelu(x):
    return torch.nn.functional.gelu(x, approximate="tanh")
def _silu(x):
    return torch.nn.functional.silu(x)
def _sigmoid(x):
    return torch.sigmoid(x)
def _layernorm(x, axis=-1, eps=1e-5):
    m = x.mean(dim=axis, keepdim=True)
    v = x.var(dim=axis, keepdim=True, unbiased=False)
    return (x - m) / torch.sqrt(v + eps)
def _scatter_add(tgt, idx, src, axis=0):
    return tgt.clone().index_add_(axis, idx, src)
def _segment_sum(src, seg, n):
    out = torch.zeros((n,) + src.shape[1:], dtype=src.dtype)
    return out.index_add_(0, seg, src)
def _pad(x, pw):
    flat = tuple(v for pair in reversed(pw) for v in pair)
    return torch.nn.functional.pad(x, flat)

kernel_name = 'recurrent_scan__mha_block_cached__geglu_ffn__decode'

def setup_inputs():

    _w = (lambda a: (lambda t: t.to(torch.bfloat16) if t.is_floating_point() else t)(torch.as_tensor(a)))
    def _A_setup():
        B, Sq, D = 4, 1, 640
        H, Sk, Dh = 32, 4096, 192
        return {
            "x": _w((lambda *s: torch.randn(*s, dtype=torch.bfloat16) * 0.05)(B, Sq, D)),
            "k_cache": _w((lambda *s: torch.randn(*s, dtype=torch.bfloat16) * 1.6)(B, H, Sk, Dh)),
            "v_cache": _w((lambda *s: torch.randn(*s, dtype=torch.bfloat16) * 0.2)(B, H, Sk, Dh)),
            "wq": _w((lambda *s: torch.randn(*s, dtype=torch.bfloat16) * 1.6)(D, H * Dh) * (D ** -0.5)),
            "wo": _w((lambda *s: torch.randn(*s, dtype=torch.bfloat16) * 0.2)(H * Dh, D) * ((H * Dh) ** -0.5)),
        }
    _A_in = _A_setup()

    def _B_setup():
        B, S, D, F = 4, 1, 640, 1536
        return {
            "x": _w((lambda *s: torch.randn(*s, dtype=torch.bfloat16) * 0.05)(B, S, D)),
            "w_gate": _w((lambda *s: torch.randn(*s, dtype=torch.bfloat16) * 0.1)(D, F)),
            "w_up": _w((lambda *s: torch.randn(*s, dtype=torch.bfloat16) * 0.1)(D, F)),
            "w_down": _w((lambda *s: torch.randn(*s, dtype=torch.bfloat16) * 0.1)(F, D)),
        }
    _B_in = _B_setup()

    return {
        "A_x": _A_in["x"],
        "A_k_cache": _A_in["k_cache"],
        "A_v_cache": _A_in["v_cache"],
        "A_wq": _A_in["wq"],
        "A_wo": _A_in["wo"],
        "B_x": _B_in["x"],
        "B_w_gate": _B_in["w_gate"],
        "B_w_up": _B_in["w_up"],
        "B_w_down": _B_in["w_down"],
    }

def reference(A_x, A_k_cache, A_v_cache, A_wq, A_wo, B_x, B_w_gate, B_w_up, B_w_down):
    def _A_ref(x, k_cache, v_cache, wq, wo):
        B, Sq, D = x.shape
        H, Dh = 32, 192
        q = (lambda x, *d: x.permute(*d))((x @ wq).reshape(B, Sq, H, Dh), 0, 2, 1, 3)
        scores = torch.einsum("bhqd,bhkd->bhqk", q, k_cache) * (Dh ** -0.5)
        p = _softmax(scores, axis=-1)
        o = torch.einsum("bhqk,bhkd->bhqd", p, v_cache)
        return (lambda x, *d: x.permute(*d))(o, 0, 2, 1, 3).reshape(B, Sq, H * Dh) @ wo

    def _B_ref(x, w_gate, w_up, w_down):
        return (_gelu(x @ w_gate) * (x @ w_up)) @ w_down

    x = A_x
    xn = _layernorm(x, axis=-1)
    s = _A_ref(xn, A_k_cache, A_v_cache, A_wq, A_wo)
    g = _silu(_B_ref(xn, B_w_gate, B_w_up, B_w_down))
    return x + s * g
```

```asm
; @launch grid=(256,1,1) block=(320,1,1) lds=102656
.amdgcn_target "amdgcn-amd-amdhsa--gfx950"
.text
.globl recurrent_scan__mha_block_cached__geglu_ffn__decode_kernel
.p2align 8
.type recurrent_scan__mha_block_cached__geglu_ffn__decode_kernel,@function
recurrent_scan__mha_block_cached__geglu_ffn__decode_kernel:
  s_cmp_ge_u32 s2, 256
  s_cbranch_scc1 L_end
  s_load_dwordx8 s[4:11], s[0:1], 0
  s_load_dwordx2 s[12:13], s[0:1], 32
  s_load_dwordx8 s[16:23], s[0:1], 48
  s_load_dwordx4 s[24:27], s[0:1], 80
  v_lshrrev_b32 v3, 6, v0
  v_and_b32 v1, 63, v0
  v_readfirstlane_b32 s3, v3
  s_mov_b32 s74, 0
  s_mov_b32 s67, 0x3f803f80
  s_mov_b32 s68, 0x05040100
  s_lshr_b32 s56, s2, 3
  s_and_b32 s57, s2, 7
  v_lshrrev_b32 v4, 5, v1
  v_and_b32 v5, 31, v1
  v_lshrrev_b32 v6, 3, v1
  v_and_b32 v7, 7, v1
  s_and_b32 s64, s56, 1
  s_lshl_b32 s64, s64, 1
  s_add_u32 s64, s64, 3
  s_and_b32 s59, s57, 1
  s_mul_i32 s64, s64, s59
  s_xor_b32 s64, s64, s57
  s_lshr_b32 s58, s64, 1
  s_lshr_b32 s64, s56, 1
  s_add_u32 s58, s58, s64
  s_and_b32 s58, s58, 3
  s_lshr_b32 s64, s56, 3
  s_and_b32 s64, s64, 1
  s_xor_b32 s59, s59, s64
  s_lshl_b32 s60, s58, 1
  s_add_u32 s60, s60, s59
  s_cmp_eq_u32 s59, 0
  s_cselect_b32 s100, s58, 8
  s_cmp_eq_u32 s60, 7
  s_cselect_b32 s100, 4, s100
  s_cmp_eq_u32 s3, 4
  s_cbranch_scc1 L_svc
  v_mul_u32_u24 v2, 384, v6
  v_lshl_add_u32 v2, v7, 4, v2
  v_mul_u32_u24 v9, 12288, v6
  v_lshl_add_u32 v9, v7, 4, v9
  s_mul_i32 s64, s3, 1280
  v_lshl_add_u32 v8, v1, 2, s64
  s_waitcnt lgkmcnt(0)
  s_load_dwordx2 s[28:29], s[26:27], 0
  global_load_dword v11, v8, s[4:5] offset:0
  global_load_dword v12, v8, s[4:5] offset:256
  global_load_dword v13, v8, s[4:5] offset:512
  global_load_dword v14, v8, s[4:5] offset:768
  global_load_dword v15, v8, s[4:5] offset:1024
  s_mov_b32 s40, s10
  s_mov_b32 s41, s11
  s_mov_b32 s42, 7864320
  s_mov_b32 s43, 0x20000
  s_cmp_ge_u32 s60, 6
  s_cbranch_scc1 L_nowq
  s_mul_i32 s64, s59, 320
  s_mul_i32 s65, s3, 80
  s_add_u32 s64, s64, s65
  s_mul_i32 s64, s64, 12288
  s_mul_i32 s66, s56, 384
  s_add_u32 s64, s64, s66
  s_lshl_b32 s66, s58, 7
  s_add_u32 s64, s64, s66
  s_lshl_b32 s65, s65, 7
  s_add_u32 s65, s65, 12544
  s_add_u32 m0, s65, 0
  s_nop 0
  buffer_load_dwordx4 v9, s[40:43], s64 offen nt lds
  s_add_u32 s64, s64, 98304
  s_add_u32 m0, s65, 1024
  s_nop 0
  buffer_load_dwordx4 v9, s[40:43], s64 offen nt lds
  s_add_u32 s64, s64, 98304
  s_add_u32 m0, s65, 2048
  s_nop 0
  buffer_load_dwordx4 v9, s[40:43], s64 offen nt lds
  s_add_u32 s64, s64, 98304
  s_add_u32 m0, s65, 3072
  s_nop 0
  buffer_load_dwordx4 v9, s[40:43], s64 offen nt lds
  s_add_u32 s64, s64, 98304
  s_add_u32 m0, s65, 4096
  s_nop 0
  buffer_load_dwordx4 v9, s[40:43], s64 offen nt lds
  s_add_u32 s64, s64, 98304
  s_add_u32 m0, s65, 5120
  s_nop 0
  buffer_load_dwordx4 v9, s[40:43], s64 offen nt lds
  s_add_u32 s64, s64, 98304
  s_add_u32 m0, s65, 6144
  s_nop 0
  buffer_load_dwordx4 v9, s[40:43], s64 offen nt lds
  s_add_u32 s64, s64, 98304
  s_add_u32 m0, s65, 7168
  s_nop 0
  buffer_load_dwordx4 v9, s[40:43], s64 offen nt lds
  s_add_u32 s64, s64, 98304
  s_add_u32 m0, s65, 8192
  s_nop 0
  buffer_load_dwordx4 v9, s[40:43], s64 offen nt lds
  s_add_u32 s64, s64, 98304
  s_add_u32 m0, s65, 9216
  s_nop 0
  buffer_load_dwordx4 v9, s[40:43], s64 offen nt lds
L_nowq:
  s_mov_b32 s32, s6
  s_mov_b32 s33, s7
  s_mov_b32 s34, 201326592
  s_mov_b32 s35, 0x20000
  s_mov_b32 s36, s8
  s_mov_b32 s37, s9
  s_mov_b32 s38, 201326592
  s_mov_b32 s39, 0x20000
  s_mov_b32 s44, s12
  s_mov_b32 s45, s13
  s_mov_b32 s46, 7864320
  s_mov_b32 s47, 0x20000
  s_lshl_b32 s64, s56, 2
  s_add_u32 s64, s64, s58
  s_lshl_b32 s64, s64, 9
  v_mov_b32 v116, 0x7ffffff0
  v_mov_b32 v3, s64
  v_cmp_eq_u32 vcc, 0, v1
  s_nop 1
  v_cndmask_b32 v116, v116, v3, vcc
  s_add_u32 s80, s26, 3473408
  s_addc_u32 s81, s27, 0
  s_mov_b32 s82, 65536
  s_mov_b32 s83, 0x20000
  buffer_load_dword v117, v116, s[80:83], 0 offen sc1
  s_mov_b32 s82, 0
  s_lshl_b32 s64, s58, 5
  s_add_u32 s64, s64, s56
  s_mul_i32 s61, s64, 1572864
  s_add_u32 s69, s61, 1351680
  s_lshl_b32 s64, s59, 2
  s_add_u32 s64, s64, s3
  s_mul_i32 s64, s64, 168960
  s_add_u32 s61, s61, s64
  s_mov_b32 s62, 3072
  v_mov_b32 v118, 1
  buffer_atomic_add v118, v116, s[80:83], 0 offen sc0 sc1
  buffer_load_dwordx4 v[160:163], v2, s[32:35], s61 offen offset:0 nt
  buffer_load_dwordx4 v[164:167], v2, s[32:35], s61 offen offset:128 nt
  buffer_load_dwordx4 v[168:171], v2, s[32:35], s61 offen offset:256 nt
  buffer_load_dwordx4 v[172:175], v2, s[36:39], s61 offen offset:0 nt
  buffer_load_dwordx4 v[176:179], v2, s[36:39], s61 offen offset:128 nt
  buffer_load_dwordx4 v[180:183], v2, s[36:39], s61 offen offset:256 nt
  s_add_u32 s61, s61, s62
  s_cmp_ge_u32 s60, 6
  s_cbranch_scc1 L_xw2
  s_waitcnt vmcnt(18)
  s_branch L_xw3
L_xw2:
  s_waitcnt vmcnt(8)
L_xw3:
  v_mov_b32 v36, 0
  v_dot2c_f32_bf16 v36, s67, v11
  v_dot2c_f32_bf16 v36, s67, v12
  v_dot2c_f32_bf16 v36, s67, v13
  v_dot2c_f32_bf16 v36, s67, v14
  v_dot2c_f32_bf16 v36, s67, v15
  v_lshlrev_b32 v16, 16, v11
  v_and_b32 v17, 0xffff0000, v11
  v_lshlrev_b32 v18, 16, v12
  v_and_b32 v19, 0xffff0000, v12
  v_lshlrev_b32 v20, 16, v13
  v_and_b32 v21, 0xffff0000, v13
  v_lshlrev_b32 v22, 16, v14
  v_and_b32 v23, 0xffff0000, v14
  v_lshlrev_b32 v24, 16, v15
  v_and_b32 v25, 0xffff0000, v15
  v_add_f32 v36, v36, v36 row_ror:1 row_mask:0xf bank_mask:0xf
  s_nop 1
  v_add_f32 v36, v36, v36 row_ror:2 row_mask:0xf bank_mask:0xf
  s_nop 1
  v_add_f32 v36, v36, v36 row_ror:4 row_mask:0xf bank_mask:0xf
  s_nop 1
  v_add_f32 v36, v36, v36 row_ror:8 row_mask:0xf bank_mask:0xf
  v_mov_b32 v37, v36
  s_nop 1
  v_permlane16_swap_b32 v36, v37
  v_add_f32 v36, v36, v37
  v_mov_b32 v37, v36
  s_nop 1
  v_permlane32_swap_b32 v36, v37
  v_add_f32 v36, v36, v37
  v_mul_f32 v38, 0x3acccccd, v36
  v_cvt_pk_bf16_f32 v39, v38, v38
  v_lshlrev_b32 v39, 16, v39
  v_mov_b32 v36, 0
  v_sub_f32 v26, v16, v38
  v_sub_f32 v27, v17, v38
  v_sub_f32 v28, v18, v38
  v_sub_f32 v29, v19, v38
  v_sub_f32 v30, v20, v38
  v_sub_f32 v31, v21, v38
  v_sub_f32 v32, v22, v38
  v_sub_f32 v33, v23, v38
  v_sub_f32 v34, v24, v38
  v_sub_f32 v35, v25, v38
  v_fmac_f32 v36, v26, v26
  v_fmac_f32 v36, v27, v27
  v_fmac_f32 v36, v28, v28
  v_fmac_f32 v36, v29, v29
  v_fmac_f32 v36, v30, v30
  v_fmac_f32 v36, v31, v31
  v_fmac_f32 v36, v32, v32
  v_fmac_f32 v36, v33, v33
  v_fmac_f32 v36, v34, v34
  v_fmac_f32 v36, v35, v35
  v_sub_f32 v26, v16, v39
  v_sub_f32 v27, v17, v39
  v_sub_f32 v28, v18, v39
  v_sub_f32 v29, v19, v39
  v_sub_f32 v30, v20, v39
  v_sub_f32 v31, v21, v39
  v_sub_f32 v32, v22, v39
  v_sub_f32 v33, v23, v39
  v_sub_f32 v34, v24, v39
  v_sub_f32 v35, v25, v39
  v_add_f32 v36, v36, v36 row_ror:1 row_mask:0xf bank_mask:0xf
  s_nop 1
  v_add_f32 v36, v36, v36 row_ror:2 row_mask:0xf bank_mask:0xf
  s_nop 1
  v_add_f32 v36, v36, v36 row_ror:4 row_mask:0xf bank_mask:0xf
  s_nop 1
  v_add_f32 v36, v36, v36 row_ror:8 row_mask:0xf bank_mask:0xf
  v_mov_b32 v37, v36
  s_nop 1
  v_permlane16_swap_b32 v36, v37
  v_add_f32 v36, v36, v37
  v_mov_b32 v37, v36
  s_nop 1
  v_permlane32_swap_b32 v36, v37
  v_add_f32 v36, v36, v37
  v_mul_f32 v36, 0x3acccccd, v36
  v_cvt_pk_bf16_f32 v36, v36, v36
  v_lshlrev_b32 v36, 16, v36
  v_add_f32 v36, 0x3727c5ac, v36
  v_cvt_pk_bf16_f32 v36, v36, v36
  v_lshlrev_b32 v36, 16, v36
  v_sqrt_f32 v36, v36
  s_nop 0
  v_cvt_pk_bf16_f32 v36, v36, v36
  v_lshlrev_b32 v36, 16, v36
  v_rcp_f32 v40, v36
  v_cvt_pk_bf16_f32 v16, v26, v27
  v_cvt_pk_bf16_f32 v17, v28, v29
  v_cvt_pk_bf16_f32 v18, v30, v31
  v_cvt_pk_bf16_f32 v19, v32, v33
  v_cvt_pk_bf16_f32 v20, v34, v35
  v_lshlrev_b32 v26, 16, v16
  v_and_b32 v27, 0xffff0000, v16
  v_lshlrev_b32 v28, 16, v17
  v_and_b32 v29, 0xffff0000, v17
  v_lshlrev_b32 v30, 16, v18
  v_and_b32 v31, 0xffff0000, v18
  v_lshlrev_b32 v32, 16, v19
  v_and_b32 v33, 0xffff0000, v19
  v_lshlrev_b32 v34, 16, v20
  v_and_b32 v35, 0xffff0000, v20
  v_mul_f32 v26, v26, v40
  v_mul_f32 v27, v27, v40
  v_mul_f32 v28, v28, v40
  v_mul_f32 v29, v29, v40
  v_mul_f32 v30, v30, v40
  v_mul_f32 v31, v31, v40
  v_mul_f32 v32, v32, v40
  v_mul_f32 v33, v33, v40
  v_mul_f32 v34, v34, v40
  v_mul_f32 v35, v35, v40
  v_cvt_pk_bf16_f32 v16, v26, v27
  v_cvt_pk_bf16_f32 v17, v28, v29
  v_cvt_pk_bf16_f32 v18, v30, v31
  v_cvt_pk_bf16_f32 v19, v32, v33
  v_cvt_pk_bf16_f32 v20, v34, v35
  s_mul_i32 s64, s3, 1344
  v_lshl_add_u32 v37, v1, 2, s64
  ds_write_b32 v37, v16 offset:0
  ds_write_b32 v37, v17 offset:256
  ds_write_b32 v37, v18 offset:512
  ds_write_b32 v37, v19 offset:768
  ds_write_b32 v37, v20 offset:1024
  v_lshrrev_b32 v3, 4, v1
  v_and_b32 v47, 3, v1
  v_mul_u32_u24 v10, 1344, v47
  v_lshl_add_u32 v10, v3, 4, v10
  s_mul_i32 s64, s59, 640
  v_add_u32 v10, s64, v10
  v_bfe_u32 v50, v1, 2, 2
  v_lshl_add_u32 v48, v3, 3, v50
  v_lshlrev_b32 v48, 7, v48
  v_lshl_add_u32 v48, v47, 3, v48
  s_lshl_b32 s64, s3, 5
  s_add_u32 s64, s64, 12544
  v_add_u32 v44, s64, v48
  s_mul_i32 s64, s56, 6
  s_add_u32 s64, s64, s60
  s_lshl_b32 s64, s64, 11
  s_lshl_b32 s65, s3, 7
  s_add_u32 s64, s64, s65
  s_add_u32 s64, s64, 1048576
  v_lshlrev_b32 v45, 9, v3
  v_bfe_u32 v49, v1, 1, 3
  v_lshl_add_u32 v45, v49, 4, v45
  v_add_u32 v45, s64, v45
  v_cmp_eq_u32 s[72:73], 1, v3
  v_cmp_eq_u32 s[70:71], 2, v3
  v_cmp_eq_u32 s[24:25], 3, v3
  s_waitcnt vmcnt(7) lgkmcnt(0)
  v_readfirstlane_b32 s75, v117
  v_mov_b32 v52, 0
  v_lshlrev_b32 v53, 2, v1
  ds_write_b32 v53, v52 offset:12160
  s_waitcnt lgkmcnt(0)
  s_add_u32 s30, s28, 1
  s_add_u32 s31, s29, 1
  s_barrier
  s_cmp_ge_u32 s60, 6
  s_cbranch_scc1 L_noq
  v_mov_b32 v96, 0
  v_mov_b32 v97, 0
  v_mov_b32 v98, 0
  v_mov_b32 v99, 0
  v_mov_b32 v100, 0
  v_mov_b32 v101, 0
  v_mov_b32 v102, 0
  v_mov_b32 v103, 0
  ds_read_b128 v[16:19], v10 offset:0
  ds_read_b64_tr_b16 v[76:77], v44 offset:0
  ds_read_b64_tr_b16 v[78:79], v44 offset:512
  ds_read_b128 v[20:23], v10 offset:64
  ds_read_b64_tr_b16 v[80:81], v44 offset:4096
  ds_read_b64_tr_b16 v[82:83], v44 offset:4608
  ds_read_b128 v[24:27], v10 offset:128
  ds_read_b64_tr_b16 v[84:85], v44 offset:8192
  ds_read_b64_tr_b16 v[86:87], v44 offset:8704
  ds_read_b128 v[28:31], v10 offset:192
  ds_read_b64_tr_b16 v[88:89], v44 offset:12288
  ds_read_b64_tr_b16 v[90:91], v44 offset:12800
  ds_read_b128 v[32:35], v10 offset:256
  ds_read_b64_tr_b16 v[92:93], v44 offset:16384
  ds_read_b64_tr_b16 v[94:95], v44 offset:16896
  ds_read_b128 v[56:59], v10 offset:320
  ds_read_b64_tr_b16 v[104:105], v44 offset:20480
  ds_read_b64_tr_b16 v[106:107], v44 offset:20992
  ds_read_b128 v[60:63], v10 offset:384
  ds_read_b64_tr_b16 v[108:109], v44 offset:24576
  ds_read_b64_tr_b16 v[110:111], v44 offset:25088
  ds_read_b128 v[64:67], v10 offset:448
  ds_read_b64_tr_b16 v[112:113], v44 offset:28672
  ds_read_b64_tr_b16 v[114:115], v44 offset:29184
  ds_read_b128 v[68:71], v10 offset:512
  ds_read_b64_tr_b16 v[36:37], v44 offset:32768
  ds_read_b64_tr_b16 v[38:39], v44 offset:33280
  ds_read_b128 v[72:75], v10 offset:576
  ds_read_b64_tr_b16 v[40:41], v44 offset:36864
  ds_read_b64_tr_b16 v[42:43], v44 offset:37376
  s_waitcnt lgkmcnt(15)
  v_mfma_f32_16x16x32_bf16 v[96:99], v[16:19], v[76:79], v[96:99]
  v_mfma_f32_16x16x32_bf16 v[100:103], v[20:23], v[80:83], v[100:103]
  s_waitcnt lgkmcnt(15)
  v_mfma_f32_16x16x32_bf16 v[96:99], v[24:27], v[84:87], v[96:99]
  v_mfma_f32_16x16x32_bf16 v[100:103], v[28:31], v[88:91], v[100:103]
  s_waitcnt lgkmcnt(12)
  v_mfma_f32_16x16x32_bf16 v[96:99], v[32:35], v[92:95], v[96:99]
  v_mfma_f32_16x16x32_bf16 v[100:103], v[56:59], v[104:107], v[100:103]
  s_waitcnt lgkmcnt(6)
  v_mfma_f32_16x16x32_bf16 v[96:99], v[60:63], v[108:111], v[96:99]
  v_mfma_f32_16x16x32_bf16 v[100:103], v[64:67], v[112:115], v[100:103]
  s_waitcnt lgkmcnt(0)
  v_mfma_f32_16x16x32_bf16 v[96:99], v[68:71], v[36:39], v[96:99]
  v_mfma_f32_16x16x32_bf16 v[100:103], v[72:75], v[40:43], v[100:103]
  s_nop 7
  v_add_f32 v96, v96, v100
  v_add_f32 v97, v97, v101
  v_add_f32 v98, v98, v102
  v_add_f32 v99, v99, v103
  v_mov_b32 v49, s30
  v_mov_b32 v51, s31
  v_cndmask_b32 v48, v96, v97, s[72:73]
  v_cndmask_b32 v48, v48, v98, s[70:71]
  v_cndmask_b32 v48, v48, v99, s[24:25]
  s_nop 1
  v_mov_b32 v50, v48 quad_perm:[1,0,3,2] row_mask:0xf bank_mask:0xf
  s_mov_b32 exec_lo, 0x55555555
  s_mov_b32 exec_hi, 0x55555555
  global_store_dwordx4 v45, v[48:51], s[26:27] sc1
  s_mov_b64 exec, -1
L_noq:
  s_mov_b32 s48, s16
  s_mov_b32 s49, s17
  s_mov_b32 s50, 1966080
  s_mov_b32 s51, 0x20000
  s_mov_b32 s52, s18
  s_mov_b32 s53, s19
  s_mov_b32 s54, 1966080
  s_mov_b32 s55, 0x20000
  s_mov_b32 s76, s20
  s_mov_b32 s77, s21
  s_mov_b32 s78, 1966080
  s_mov_b32 s79, 0x20000
  s_cmp_ge_u32 s100, 8
  s_cbranch_scc1 L_nowo
  v_lshrrev_b32 v3, 4, v1
  v_mul_u32_u24 v41, 1280, v3
  v_and_b32 v42, 15, v1
  v_lshl_add_u32 v41, v42, 4, v41
  s_mul_i32 s64, s56, 192
  s_mul_i32 s65, s3, 48
  s_add_u32 s64, s64, s65
  s_mul_i32 s64, s64, 1280
  s_lshl_b32 s66, s100, 8
  s_add_u32 s64, s64, s66
  s_mul_i32 s65, s3, 12288
  s_add_u32 s65, s65, 53504
  s_add_u32 m0, s65, 0
  s_waitcnt vmcnt(7)
  buffer_load_dwordx4 v41, s[44:47], s64 offen nt lds
  s_add_u32 s64, s64, 5120
  s_add_u32 m0, s65, 1024
  s_waitcnt vmcnt(7)
  buffer_load_dwordx4 v41, s[44:47], s64 offen nt lds
  s_add_u32 s64, s64, 5120
  s_add_u32 m0, s65, 2048
  s_waitcnt vmcnt(7)
  buffer_load_dwordx4 v41, s[44:47], s64 offen nt lds
  s_add_u32 s64, s64, 5120
  s_add_u32 m0, s65, 3072
  s_waitcnt vmcnt(7)
  buffer_load_dwordx4 v41, s[44:47], s64 offen nt lds
  s_add_u32 s64, s64, 5120
  s_add_u32 m0, s65, 4096
  s_waitcnt vmcnt(7)
  buffer_load_dwordx4 v41, s[44:47], s64 offen nt lds
  s_add_u32 s64, s64, 5120
  s_add_u32 m0, s65, 5120
  s_waitcnt vmcnt(7)
  buffer_load_dwordx4 v41, s[44:47], s64 offen nt lds
  s_add_u32 s64, s64, 5120
  s_add_u32 m0, s65, 6144
  s_waitcnt vmcnt(7)
  buffer_load_dwordx4 v41, s[44:47], s64 offen nt lds
  s_add_u32 s64, s64, 5120
  s_add_u32 m0, s65, 7168
  s_waitcnt vmcnt(7)
  buffer_load_dwordx4 v41, s[44:47], s64 offen nt lds
  s_add_u32 s64, s64, 5120
  s_add_u32 m0, s65, 8192
  s_waitcnt vmcnt(7)
  buffer_load_dwordx4 v41, s[44:47], s64 offen nt lds
  s_add_u32 s64, s64, 5120
  s_add_u32 m0, s65, 9216
  s_waitcnt vmcnt(7)
  buffer_load_dwordx4 v41, s[44:47], s64 offen nt lds
  s_add_u32 s64, s64, 5120
  s_add_u32 m0, s65, 10240
  s_waitcnt vmcnt(7)
  buffer_load_dwordx4 v41, s[44:47], s64 offen nt lds
  s_add_u32 s64, s64, 5120
  s_add_u32 m0, s65, 11264
  s_waitcnt vmcnt(7)
  buffer_load_dwordx4 v41, s[44:47], s64 offen nt lds
  s_cmp_lt_u32 s60, 6
  s_cbranch_scc1 L_stg_done
  s_lshl_b32 s64, s56, 1
  s_add_u32 s64, s64, s59
  s_cmp_ge_u32 s64, 60
  s_cbranch_scc1 L_stg_done
  s_mul_i32 s65, s64, 52
  s_lshr_b32 s65, s65, 8
  s_mul_i32 s66, s65, 5
  s_sub_u32 s66, s64, s66
  s_lshl_b32 s64, s65, 7
  s_lshl_b32 s65, s3, 5
  s_add_u32 s64, s64, s65
  s_mul_i32 s64, s64, 1280
  s_lshl_b32 s66, s66, 8
  s_add_u32 s64, s64, s66
  s_lshl_b32 s65, s3, 13
  s_add_u32 s65, s65, 12544
  s_add_u32 m0, s65, 0
  s_waitcnt vmcnt(7)
  buffer_load_dwordx4 v41, s[76:79], s64 offen nt lds
  s_add_u32 s64, s64, 5120
  s_add_u32 m0, s65, 1024
  s_waitcnt vmcnt(7)
  buffer_load_dwordx4 v41, s[76:79], s64 offen nt lds
  s_add_u32 s64, s64, 5120
  s_add_u32 m0, s65, 2048
  s_waitcnt vmcnt(7)
  buffer_load_dwordx4 v41, s[76:79], s64 offen nt lds
  s_add_u32 s64, s64, 5120
  s_add_u32 m0, s65, 3072
  s_waitcnt vmcnt(7)
  buffer_load_dwordx4 v41, s[76:79], s64 offen nt lds
  s_add_u32 s64, s64, 5120
  s_add_u32 m0, s65, 4096
  s_waitcnt vmcnt(7)
  buffer_load_dwordx4 v41, s[76:79], s64 offen nt lds
  s_add_u32 s64, s64, 5120
  s_add_u32 m0, s65, 5120
  s_waitcnt vmcnt(7)
  buffer_load_dwordx4 v41, s[76:79], s64 offen nt lds
  s_add_u32 s64, s64, 5120
  s_add_u32 m0, s65, 6144
  s_waitcnt vmcnt(7)
  buffer_load_dwordx4 v41, s[76:79], s64 offen nt lds
  s_add_u32 s64, s64, 5120
  s_add_u32 m0, s65, 7168
  s_waitcnt vmcnt(7)
  buffer_load_dwordx4 v41, s[76:79], s64 offen nt lds
  s_branch L_stg_done
L_nowo:
  s_mul_i32 s64, s56, 3
  s_add_u32 s64, s64, s58
  s_lshr_b32 s65, s64, 2
  s_and_b32 s64, s64, 3
  s_mul_i32 s64, s64, 160
  s_mul_i32 s66, s3, 40
  s_add_u32 s64, s64, s66
  s_mul_i32 s64, s64, 3072
  s_lshl_b32 s65, s65, 7
  s_add_u32 s64, s64, s65
  s_lshl_b32 s65, s66, 7
  s_add_u32 s65, s65, 53504
  v_mul_u32_u24 v41, 3072, v6
  v_lshl_add_u32 v41, v7, 4, v41
  s_add_u32 m0, s65, 0
  s_waitcnt vmcnt(7)
  buffer_load_dwordx4 v41, s[48:51], s64 offen nt lds
  s_add_u32 m0, s65, 20480
  s_waitcnt vmcnt(7)
  buffer_load_dwordx4 v41, s[52:55], s64 offen nt lds
  s_add_u32 s64, s64, 24576
  s_add_u32 m0, s65, 1024
  s_waitcnt vmcnt(7)
  buffer_load_dwordx4 v41, s[48:51], s64 offen nt lds
  s_add_u32 m0, s65, 21504
  s_waitcnt vmcnt(7)
  buffer_load_dwordx4 v41, s[52:55], s64 offen nt lds
  s_add_u32 s64, s64, 24576
  s_add_u32 m0, s65, 2048
  s_waitcnt vmcnt(7)
  buffer_load_dwordx4 v41, s[48:51], s64 offen nt lds
  s_add_u32 m0, s65, 22528
  s_waitcnt vmcnt(7)
  buffer_load_dwordx4 v41, s[52:55], s64 offen nt lds
  s_add_u32 s64, s64, 24576
  s_add_u32 m0, s65, 3072
  s_waitcnt vmcnt(7)
  buffer_load_dwordx4 v41, s[48:51], s64 offen nt lds
  s_add_u32 m0, s65, 23552
  s_waitcnt vmcnt(7)
  buffer_load_dwordx4 v41, s[52:55], s64 offen nt lds
  s_add_u32 s64, s64, 24576
  s_add_u32 m0, s65, 4096
  s_waitcnt vmcnt(7)
  buffer_load_dwordx4 v41, s[48:51], s64 offen nt lds
  s_add_u32 m0, s65, 24576
  s_waitcnt vmcnt(7)
  buffer_load_dwordx4 v41, s[52:55], s64 offen nt lds
L_stg_done:
  v_mov_b32 v119, 1
  buffer_atomic_add v119, v116, s[80:83], 0 offen sc0 sc1
  s_waitcnt vmcnt(7)
  buffer_load_dwordx4 v[184:187], v2, s[32:35], s61 offen offset:0 nt
  s_waitcnt vmcnt(7)
  buffer_load_dwordx4 v[188:191], v2, s[32:35], s61 offen offset:128 nt
  s_waitcnt vmcnt(7)
  buffer_load_dwordx4 v[192:195], v2, s[32:35], s61 offen offset:256 nt
  s_waitcnt vmcnt(7)
  buffer_load_dwordx4 v[196:199], v2, s[36:39], s61 offen offset:0 nt
  s_waitcnt vmcnt(7)
  buffer_load_dwordx4 v[200:203], v2, s[36:39], s61 offen offset:128 nt
  s_waitcnt vmcnt(7)
  buffer_load_dwordx4 v[204:207], v2, s[36:39], s61 offen offset:256 nt
  s_add_u32 s61, s61, s62
  v_lshrrev_b32 v8, 4, v1
  v_mul_u32_u24 v9, 6, v8
  s_mul_i32 s64, s3, 800
  s_add_u32 s64, s64, 7168
  v_lshl_add_u32 v10, v7, 5, s64
  v_add_u32 v11, 0, v9
  v_lshrrev_b32 v12, 3, v11
  v_and_b32 v11, 7, v11
  v_lshlrev_b32 v12, 8, v12
  v_lshl_add_u32 v12, v11, 2, v12
  v_add_u32 v56, v12, v10
  v_add_u32 v11, 2, v9
  v_lshrrev_b32 v12, 3, v11
  v_and_b32 v11, 7, v11
  v_lshlrev_b32 v12, 8, v12
  v_lshl_add_u32 v12, v11, 2, v12
  v_add_u32 v57, v12, v10
  v_add_u32 v11, 4, v9
  v_lshrrev_b32 v12, 3, v11
  v_and_b32 v11, 7, v11
  v_lshlrev_b32 v12, 8, v12
  v_lshl_add_u32 v12, v11, 2, v12
  v_add_u32 v58, v12, v10
  v_mov_b32 v59, s64
  v_lshlrev_b32 v60, 3, v0
  v_mov_b32 v61, 7936
  s_lshl_b32 s64, s56, 3
  s_add_u32 s65, s64, s60
  s_lshl_b32 s65, s65, 11
  s_add_u32 s65, s65, 1572864
  v_lshl_add_u32 v62, v0, 4, s65
  s_lshl_b32 s65, s3, 1
  s_add_u32 s64, s64, s65
  s_lshl_b32 s64, s64, 11
  s_add_u32 s64, s64, 1572864
  v_lshlrev_b32 v9, 11, v4
  v_add_u32 v9, s64, v9
  v_lshl_add_u32 v63, v5, 4, v9
  v_add_u32 v64, 1536, v9
  v_bfe_u32 v9, v1, 2, 2
  v_lshl_add_u32 v10, v8, 3, v9
  v_lshlrev_b32 v10, 8, v10
  v_and_b32 v11, 3, v1
  v_lshl_add_u32 v10, v11, 3, v10
  s_lshl_b32 s64, s3, 6
  s_add_u32 s64, s64, 53504
  v_add_u32 v65, s64, v10
  v_lshlrev_b32 v10, 12, v9
  v_and_b32 v12, 1, v8
  v_lshl_add_u32 v10, v12, 6, v10
  v_lshl_add_u32 v10, v11, 4, v10
  s_and_b32 s66, s100, 7
  s_lshl_b32 s64, s66, 5
  s_lshl_b32 s65, s3, 3
  s_add_u32 s64, s64, s65
  s_lshl_b32 s64, s64, 12
  s_lshl_b32 s65, s56, 7
  s_add_u32 s64, s64, s65
  s_add_u32 s64, s64, 2097152
  v_add_u32 v66, s64, v10
  v_add_u32 v67, 16384, v66
  s_lshl_b32 s64, s66, 5
  s_add_u32 s64, s64, s56
  s_lshl_b32 s64, s64, 12
  s_add_u32 s64, s64, 2097152
  v_lshl_add_u32 v68, v1, 4, s64
  v_bfe_u32 v9, v1, 2, 1
  v_and_b32 v10, 1, v6
  v_lshl_add_u32 v9, v9, 1, v10
  v_lshlrev_b32 v71, 4, v11
  v_lshl_add_u32 v71, v9, 2, v71
  v_mul_u32_u24 v9, 640, v9
  s_min_u32 s66, s66, 4
  s_lshl_b32 s64, s66, 7
  s_lshl_b32 s65, s56, 2
  s_add_u32 s64, s64, s65
  v_add3_u32 v9, v9, v11, s64
  v_lshlrev_b32 v69, 1, v9
  global_load_ushort v70, v69, s[4:5]
  s_mul_i32 s64, s3, 448
  v_lshl_add_u32 v72, v1, 2, s64
  v_lshl_add_u32 v73, v5, 2, s64
  v_mul_u32_u24 v74, 448, v11
  v_lshl_add_u32 v74, v8, 4, v74
  v_lshlrev_b32 v3, 4, v7
  v_mov_b32 v136, 0
  v_mov_b32 v137, 0
  v_mov_b32 v138, 0
  v_mov_b32 v139, 0
  v_mov_b32 v140, 0
  v_mov_b32 v141, 0
  v_mov_b32 v142, 0
  v_mov_b32 v143, 0
  v_mov_b32 v144, 0
  v_mov_b32 v145, 0
  v_mov_b32 v146, 0
  v_mov_b32 v147, 0
  v_mov_b32 v148, 0
  v_mov_b32 v149, 0
  v_mov_b32 v150, 0
  v_mov_b32 v151, 0
  v_mov_b32 v152, 0
  v_mov_b32 v153, 0
  v_mov_b32 v154, 0
  v_mov_b32 v155, 0
  v_mov_b32 v156, 0
  v_mov_b32 v157, 0
  v_mov_b32 v158, 0
  v_mov_b32 v159, 0
  v_mov_b32 v122, 0xff800000
  v_mov_b32 v123, 0
  s_waitcnt vmcnt(8)
  s_barrier
  ds_read_b128 v[124:127], v3 offset:5376
  ds_read_b128 v[128:131], v3 offset:5504
  ds_read_b128 v[132:135], v3 offset:5632
  s_mov_b32 s63, 0
  s_mov_b32 s15, 2
  s_mov_b32 s14, 1
  s_mov_b32 s101, 0
  s_waitcnt lgkmcnt(0)
L_loop:
  v_mov_b32 v100, 0
  v_mov_b32 v101, 0
  v_mov_b32 v102, 0
  s_waitcnt vmcnt(10)
  v_readfirstlane_b32 s64, v118
  v_dot2c_f32_bf16 v100, v160, v124
  v_dot2c_f32_bf16 v101, v164, v128
  v_dot2c_f32_bf16 v102, v168, v132
  v_dot2c_f32_bf16 v100, v161, v125
  v_dot2c_f32_bf16 v101, v165, v129
  v_dot2c_f32_bf16 v102, v169, v133
  v_dot2c_f32_bf16 v100, v162, v126
  v_dot2c_f32_bf16 v101, v166, v130
  v_dot2c_f32_bf16 v102, v170, v134
  v_dot2c_f32_bf16 v100, v163, v127
  v_dot2c_f32_bf16 v101, v167, v131
  v_dot2c_f32_bf16 v102, v171, v135
  s_cmp_lt_u32 s63, 53
  s_cbranch_scc1 L_st0
  s_cmp_eq_u32 s14, 0
  s_cbranch_scc1 L_st0
  s_sub_u32 s65, s63, 53
  s_lshl_b32 s65, s65, 2
  v_mov_b32 v109, s65
  s_cmp_lg_u32 s3, 0
  s_cbranch_scc1 L_rd0
  s_sub_u32 s64, s64, s75
  s_add_u32 s65, s64, 1
  s_cmp_lt_u32 s64, 18
  s_cselect_b32 s64, s65, 0xffff
  v_mov_b32 v110, s64
  ds_write_b32 v109, v110 offset:12160
  s_branch L_hv0
L_rd0:
  ds_read_b32 v110, v109 offset:12160
  s_add_u32 s101, s101, 1
  s_cmp_gt_u32 s101, 0x400000
  s_cbranch_scc1 L_end
  s_waitcnt lgkmcnt(0)
  v_readfirstlane_b32 s64, v110
  s_nop 0
  s_cmp_eq_u32 s64, 0
  s_cbranch_scc1 L_rd0
L_hv0:
  s_lshl_b32 s65, s64, 2
  s_add_u32 s65, s65, s3
  s_sub_u32 s65, s65, 4
  s_mul_i32 s65, s65, 3072
  s_add_u32 s61, s65, s69
  s_cmp_lg_u32 s64, 0xffff
  s_cselect_b32 s14, 1, 0
L_st0:
  s_add_u32 s15, s15, s14
  s_cmp_eq_u32 s14, 0
  s_cselect_b32 s34, 0, s34
  s_cselect_b32 s38, 0, s38
  s_cmp_ge_u32 s63, 51
  s_cselect_b32 s64, s14, 0
  s_cmp_eq_u32 s3, 0
  s_cselect_b32 s64, s64, 0
  s_lshl_b32 s82, s64, 16
  v_mov_b32 v118, 1
  buffer_atomic_add v118, v116, s[80:83], 0 offen sc0 sc1
  buffer_load_dwordx4 v[160:163], v2, s[32:35], s61 offen offset:0 nt
  buffer_load_dwordx4 v[164:167], v2, s[32:35], s61 offen offset:128 nt
  buffer_load_dwordx4 v[168:171], v2, s[32:35], s61 offen offset:256 nt
  v_add_f32 v100, v100, v101
  v_add_f32 v100, v100, v102
  s_nop 1
  v_add_f32 v100, v100, v100 quad_perm:[1,0,3,2] row_mask:0xf bank_mask:0xf
  s_nop 1
  v_add_f32 v100, v100, v100 quad_perm:[2,3,0,1] row_mask:0xf bank_mask:0xf
  s_nop 1
  v_add_f32 v100, v100, v100 row_half_mirror row_mask:0xf bank_mask:0xf
  v_cvt_pk_bf16_f32 v101, v100, v100
  v_lshlrev_b32 v101, 16, v101
  v_mul_f32 v101, 0x3d93cd3a, v101
  v_cvt_pk_bf16_f32 v103, v101, v101
  v_lshlrev_b32 v103, 16, v103
  s_nop 1
  v_max_f32 v104, v103, v103 row_ror:8 row_mask:0xf bank_mask:0xf
  v_mov_b32 v105, v104
  s_nop 1
  v_permlane16_swap_b32 v104, v105
  v_max_f32 v104, v104, v105
  v_mov_b32 v105, v104
  s_nop 1
  v_permlane32_swap_b32 v104, v105
  v_max_f32 v104, v104, v105
  v_cmp_gt_f32 vcc, v104, v122
  v_max_f32 v104, v122, v104
  v_sub_f32 v105, v122, v104
  v_sub_f32 v106, v103, v104
  v_mul_f32 v105, 0x3fb8aa3b, v105
  v_mul_f32 v106, 0x3fb8aa3b, v106
  v_exp_f32 v105, v105
  v_exp_f32 v106, v106
  v_mov_b32 v122, v104
  v_fma_f32 v123, v123, v105, v106
  s_cbranch_vccz L_nors0
  v_mul_f32 v136, v136, v105
  v_mul_f32 v137, v137, v105
  v_mul_f32 v138, v138, v105
  v_mul_f32 v139, v139, v105
  v_mul_f32 v140, v140, v105
  v_mul_f32 v141, v141, v105
  v_mul_f32 v142, v142, v105
  v_mul_f32 v143, v143, v105
  v_mul_f32 v144, v144, v105
  v_mul_f32 v145, v145, v105
  v_mul_f32 v146, v146, v105
  v_mul_f32 v147, v147, v105
  v_mul_f32 v148, v148, v105
  v_mul_f32 v149, v149, v105
  v_mul_f32 v150, v150, v105
  v_mul_f32 v151, v151, v105
  v_mul_f32 v152, v152, v105
  v_mul_f32 v153, v153, v105
  v_mul_f32 v154, v154, v105
  v_mul_f32 v155, v155, v105
  v_mul_f32 v156, v156, v105
  v_mul_f32 v157, v157, v105
  v_mul_f32 v158, v158, v105
  v_mul_f32 v159, v159, v105
L_nors0:
  s_waitcnt vmcnt(11)
  v_lshlrev_b32 v110, 16, v172
  v_and_b32 v111, 0xffff0000, v172
  v_lshlrev_b32 v112, 16, v173
  v_and_b32 v113, 0xffff0000, v173
  v_pk_fma_f32 v[136:137], v[110:111], v[106:107], v[136:137] op_sel_hi:[1,0,1]
  v_lshlrev_b32 v114, 16, v174
  v_and_b32 v115, 0xffff0000, v174
  v_pk_fma_f32 v[138:139], v[112:113], v[106:107], v[138:139] op_sel_hi:[1,0,1]
  v_lshlrev_b32 v110, 16, v175
  v_and_b32 v111, 0xffff0000, v175
  v_pk_fma_f32 v[140:141], v[114:115], v[106:107], v[140:141] op_sel_hi:[1,0,1]
  v_lshlrev_b32 v112, 16, v176
  v_and_b32 v113, 0xffff0000, v176
  v_pk_fma_f32 v[142:143], v[110:111], v[106:107], v[142:143] op_sel_hi:[1,0,1]
  v_lshlrev_b32 v114, 16, v177
  v_and_b32 v115, 0xffff0000, v177
  v_pk_fma_f32 v[144:145], v[112:113], v[106:107], v[144:145] op_sel_hi:[1,0,1]
  v_lshlrev_b32 v110, 16, v178
  v_and_b32 v111, 0xffff0000, v178
  v_pk_fma_f32 v[146:147], v[114:115], v[106:107], v[146:147] op_sel_hi:[1,0,1]
  v_lshlrev_b32 v112, 16, v179
  v_and_b32 v113, 0xffff0000, v179
  v_pk_fma_f32 v[148:149], v[110:111], v[106:107], v[148:149] op_sel_hi:[1,0,1]
  v_lshlrev_b32 v114, 16, v180
  v_and_b32 v115, 0xffff0000, v180
  v_pk_fma_f32 v[150:151], v[112:113], v[106:107], v[150:151] op_sel_hi:[1,0,1]
  v_lshlrev_b32 v110, 16, v181
  v_and_b32 v111, 0xffff0000, v181
  v_pk_fma_f32 v[152:153], v[114:115], v[106:107], v[152:153] op_sel_hi:[1,0,1]
  v_lshlrev_b32 v112, 16, v182
  v_and_b32 v113, 0xffff0000, v182
  v_pk_fma_f32 v[154:155], v[110:111], v[106:107], v[154:155] op_sel_hi:[1,0,1]
  v_lshlrev_b32 v114, 16, v183
  v_and_b32 v115, 0xffff0000, v183
  v_pk_fma_f32 v[156:157], v[112:113], v[106:107], v[156:157] op_sel_hi:[1,0,1]
  v_pk_fma_f32 v[158:159], v[114:115], v[106:107], v[158:159] op_sel_hi:[1,0,1]
  buffer_load_dwordx4 v[172:175], v2, s[36:39], s61 offen offset:0 nt
  buffer_load_dwordx4 v[176:179], v2, s[36:39], s61 offen offset:128 nt
  buffer_load_dwordx4 v[180:183], v2, s[36:39], s61 offen offset:256 nt
  s_add_u32 s61, s61, s62
  s_add_u32 s63, s63, 1
  s_cmp_lt_u32 s63, s15
  s_cbranch_scc0 L_tail
  v_mov_b32 v100, 0
  v_mov_b32 v101, 0
  v_mov_b32 v102, 0
  s_waitcnt vmcnt(10)
  v_readfirstlane_b32 s64, v119
  v_dot2c_f32_bf16 v100, v184, v124
  v_dot2c_f32_bf16 v101, v188, v128
  v_dot2c_f32_bf16 v102, v192, v132
  v_dot2c_f32_bf16 v100, v185, v125
  v_dot2c_f32_bf16 v101, v189, v129
  v_dot2c_f32_bf16 v102, v193, v133
  v_dot2c_f32_bf16 v100, v186, v126
  v_dot2c_f32_bf16 v101, v190, v130
  v_dot2c_f32_bf16 v102, v194, v134
  v_dot2c_f32_bf16 v100, v187, v127
  v_dot2c_f32_bf16 v101, v191, v131
  v_dot2c_f32_bf16 v102, v195, v135
  s_cmp_lt_u32 s63, 53
  s_cbranch_scc1 L_st1
  s_cmp_eq_u32 s14, 0
  s_cbranch_scc1 L_st1
  s_sub_u32 s65, s63, 53
  s_lshl_b32 s65, s65, 2
  v_mov_b32 v109, s65
  s_cmp_lg_u32 s3, 0
  s_cbranch_scc1 L_rd1
  s_sub_u32 s64, s64, s75
  s_add_u32 s65, s64, 1
  s_cmp_lt_u32 s64, 18
  s_cselect_b32 s64, s65, 0xffff
  v_mov_b32 v110, s64
  ds_write_b32 v109, v110 offset:12160
  s_branch L_hv1
L_rd1:
  ds_read_b32 v110, v109 offset:12160
  s_add_u32 s101, s101, 1
  s_cmp_gt_u32 s101, 0x400000
  s_cbranch_scc1 L_end
  s_waitcnt lgkmcnt(0)
  v_readfirstlane_b32 s64, v110
  s_nop 0
  s_cmp_eq_u32 s64, 0
  s_cbranch_scc1 L_rd1
L_hv1:
  s_lshl_b32 s65, s64, 2
  s_add_u32 s65, s65, s3
  s_sub_u32 s65, s65, 4
  s_mul_i32 s65, s65, 3072
  s_add_u32 s61, s65, s69
  s_cmp_lg_u32 s64, 0xffff
  s_cselect_b32 s14, 1, 0
L_st1:
  s_add_u32 s15, s15, s14
  s_cmp_eq_u32 s14, 0
  s_cselect_b32 s34, 0, s34
  s_cselect_b32 s38, 0, s38
  s_cmp_ge_u32 s63, 51
  s_cselect_b32 s64, s14, 0
  s_cmp_eq_u32 s3, 0
  s_cselect_b32 s64, s64, 0
  s_lshl_b32 s82, s64, 16
  v_mov_b32 v119, 1
  buffer_atomic_add v119, v116, s[80:83], 0 offen sc0 sc1
  buffer_load_dwordx4 v[184:187], v2, s[32:35], s61 offen offset:0 nt
  buffer_load_dwordx4 v[188:191], v2, s[32:35], s61 offen offset:128 nt
  buffer_load_dwordx4 v[192:195], v2, s[32:35], s61 offen offset:256 nt
  v_add_f32 v100, v100, v101
  v_add_f32 v100, v100, v102
  s_nop 1
  v_add_f32 v100, v100, v100 quad_perm:[1,0,3,2] row_mask:0xf bank_mask:0xf
  s_nop 1
  v_add_f32 v100, v100, v100 quad_perm:[2,3,0,1] row_mask:0xf bank_mask:0xf
  s_nop 1
  v_add_f32 v100, v100, v100 row_half_mirror row_mask:0xf bank_mask:0xf
  v_cvt_pk_bf16_f32 v101, v100, v100
  v_lshlrev_b32 v101, 16, v101
  v_mul_f32 v101, 0x3d93cd3a, v101
  v_cvt_pk_bf16_f32 v103, v101, v101
  v_lshlrev_b32 v103, 16, v103
  s_nop 1
  v_max_f32 v104, v103, v103 row_ror:8 row_mask:0xf bank_mask:0xf
  v_mov_b32 v105, v104
  s_nop 1
  v_permlane16_swap_b32 v104, v105
  v_max_f32 v104, v104, v105
  v_mov_b32 v105, v104
  s_nop 1
  v_permlane32_swap_b32 v104, v105
  v_max_f32 v104, v104, v105
  v_cmp_gt_f32 vcc, v104, v122
  v_max_f32 v104, v122, v104
  v_sub_f32 v105, v122, v104
  v_sub_f32 v106, v103, v104
  v_mul_f32 v105, 0x3fb8aa3b, v105
  v_mul_f32 v106, 0x3fb8aa3b, v106
  v_exp_f32 v105, v105
  v_exp_f32 v106, v106
  v_mov_b32 v122, v104
  v_fma_f32 v123, v123, v105, v106
  s_cbranch_vccz L_nors1
  v_mul_f32 v136, v136, v105
  v_mul_f32 v137, v137, v105
  v_mul_f32 v138, v138, v105
  v_mul_f32 v139, v139, v105
  v_mul_f32 v140, v140, v105
  v_mul_f32 v141, v141, v105
  v_mul_f32 v142, v142, v105
  v_mul_f32 v143, v143, v105
  v_mul_f32 v144, v144, v105
  v_mul_f32 v145, v145, v105
  v_mul_f32 v146, v146, v105
  v_mul_f32 v147, v147, v105
  v_mul_f32 v148, v148, v105
  v_mul_f32 v149, v149, v105
  v_mul_f32 v150, v150, v105
  v_mul_f32 v151, v151, v105
  v_mul_f32 v152, v152, v105
  v_mul_f32 v153, v153, v105
  v_mul_f32 v154, v154, v105
  v_mul_f32 v155, v155, v105
  v_mul_f32 v156, v156, v105
  v_mul_f32 v157, v157, v105
  v_mul_f32 v158, v158, v105
  v_mul_f32 v159, v159, v105
L_nors1:
  s_waitcnt vmcnt(11)
  v_lshlrev_b32 v110, 16, v196
  v_and_b32 v111, 0xffff0000, v196
  v_lshlrev_b32 v112, 16, v197
  v_and_b32 v113, 0xffff0000, v197
  v_pk_fma_f32 v[136:137], v[110:111], v[106:107], v[136:137] op_sel_hi:[1,0,1]
  v_lshlrev_b32 v114, 16, v198
  v_and_b32 v115, 0xffff0000, v198
  v_pk_fma_f32 v[138:139], v[112:113], v[106:107], v[138:139] op_sel_hi:[1,0,1]
  v_lshlrev_b32 v110, 16, v199
  v_and_b32 v111, 0xffff0000, v199
  v_pk_fma_f32 v[140:141], v[114:115], v[106:107], v[140:141] op_sel_hi:[1,0,1]
  v_lshlrev_b32 v112, 16, v200
  v_and_b32 v113, 0xffff0000, v200
  v_pk_fma_f32 v[142:143], v[110:111], v[106:107], v[142:143] op_sel_hi:[1,0,1]
  v_lshlrev_b32 v114, 16, v201
  v_and_b32 v115, 0xffff0000, v201
  v_pk_fma_f32 v[144:145], v[112:113], v[106:107], v[144:145] op_sel_hi:[1,0,1]
  v_lshlrev_b32 v110, 16, v202
  v_and_b32 v111, 0xffff0000, v202
  v_pk_fma_f32 v[146:147], v[114:115], v[106:107], v[146:147] op_sel_hi:[1,0,1]
  v_lshlrev_b32 v112, 16, v203
  v_and_b32 v113, 0xffff0000, v203
  v_pk_fma_f32 v[148:149], v[110:111], v[106:107], v[148:149] op_sel_hi:[1,0,1]
  v_lshlrev_b32 v114, 16, v204
  v_and_b32 v115, 0xffff0000, v204
  v_pk_fma_f32 v[150:151], v[112:113], v[106:107], v[150:151] op_sel_hi:[1,0,1]
  v_lshlrev_b32 v110, 16, v205
  v_and_b32 v111, 0xffff0000, v205
  v_pk_fma_f32 v[152:153], v[114:115], v[106:107], v[152:153] op_sel_hi:[1,0,1]
  v_lshlrev_b32 v112, 16, v206
  v_and_b32 v113, 0xffff0000, v206
  v_pk_fma_f32 v[154:155], v[110:111], v[106:107], v[154:155] op_sel_hi:[1,0,1]
  v_lshlrev_b32 v114, 16, v207
  v_and_b32 v115, 0xffff0000, v207
  v_pk_fma_f32 v[156:157], v[112:113], v[106:107], v[156:157] op_sel_hi:[1,0,1]
  v_pk_fma_f32 v[158:159], v[114:115], v[106:107], v[158:159] op_sel_hi:[1,0,1]
  buffer_load_dwordx4 v[196:199], v2, s[36:39], s61 offen offset:0 nt
  buffer_load_dwordx4 v[200:203], v2, s[36:39], s61 offen offset:128 nt
  buffer_load_dwordx4 v[204:207], v2, s[36:39], s61 offen offset:256 nt
  s_add_u32 s61, s61, s62
  s_add_u32 s63, s63, 1
  s_cmp_lt_u32 s63, s15
  s_cbranch_scc1 L_loop
L_tail:
  v_mov_b32 v100, v122
  v_add_f32 v123, v123, v123 row_ror:8 row_mask:0xf bank_mask:0xf
  v_permlane32_swap_b32 v136, v148
  v_permlane32_swap_b32 v137, v149
  v_permlane32_swap_b32 v138, v150
  v_permlane32_swap_b32 v139, v151
  v_permlane32_swap_b32 v140, v152
  v_permlane32_swap_b32 v141, v153
  v_permlane32_swap_b32 v142, v154
  v_permlane32_swap_b32 v143, v155
  v_permlane32_swap_b32 v144, v156
  v_permlane32_swap_b32 v145, v157
  v_permlane32_swap_b32 v146, v158
  v_permlane32_swap_b32 v147, v159
  v_mov_b32 v101, v123
  s_nop 1
  v_permlane16_swap_b32 v123, v101
  v_add_f32 v136, v136, v148
  v_add_f32 v137, v137, v149
  v_add_f32 v138, v138, v150
  v_add_f32 v139, v139, v151
  v_add_f32 v140, v140, v152
  v_add_f32 v141, v141, v153
  v_add_f32 v142, v142, v154
  v_add_f32 v143, v143, v155
  v_add_f32 v144, v144, v156
  v_add_f32 v145, v145, v157
  v_add_f32 v146, v146, v158
  v_add_f32 v147, v147, v159
  v_add_f32 v123, v123, v101
  v_permlane16_swap_b32 v136, v142
  v_permlane16_swap_b32 v137, v143
  v_permlane16_swap_b32 v138, v144
  v_permlane16_swap_b32 v139, v145
  v_permlane16_swap_b32 v140, v146
  v_permlane16_swap_b32 v141, v147
  v_mov_b32 v101, v123
  s_nop 1
  v_permlane32_swap_b32 v123, v101
  v_add_f32 v136, v136, v142
  v_add_f32 v137, v137, v143
  v_add_f32 v138, v138, v144
  v_add_f32 v139, v139, v145
  v_add_f32 v140, v140, v146
  v_add_f32 v141, v141, v147
  v_add_f32 v101, v123, v101
  v_add_f32 v136, v136, v136 row_ror:8 row_mask:0xf bank_mask:0xf
  v_add_f32 v137, v137, v137 row_ror:8 row_mask:0xf bank_mask:0xf
  v_add_f32 v138, v138, v138 row_ror:8 row_mask:0xf bank_mask:0xf
  v_add_f32 v139, v139, v139 row_ror:8 row_mask:0xf bank_mask:0xf
  v_add_f32 v140, v140, v140 row_ror:8 row_mask:0xf bank_mask:0xf
  v_add_f32 v141, v141, v141 row_ror:8 row_mask:0xf bank_mask:0xf
  ds_write_b64 v56, v[136:137]
  ds_write_b64 v57, v[138:139]
  ds_write_b64 v58, v[140:141]
  ds_write_b64 v59, v[100:101] offset:768
  s_waitcnt lgkmcnt(0)
  s_barrier
  s_cmp_ge_u32 s3, 2
  s_cbranch_scc1 L_nomerge
  ds_read_b64 v[108:109], v61 offset:0
  ds_read_b64 v[110:111], v61 offset:800
  ds_read_b64 v[112:113], v61 offset:1600
  ds_read_b64 v[114:115], v61 offset:2400
  ds_read_b64 v[100:101], v60 offset:7168
  ds_read_b64 v[102:103], v60 offset:7968
  ds_read_b64 v[104:105], v60 offset:8768
  ds_read_b64 v[106:107], v60 offset:9568
  v_cmp_eq_u32 vcc, 96, v0
  s_nop 0
  s_mov_b64 s[70:71], vcc
  v_cmp_ge_u32 vcc, 96, v0
  s_nop 0
  s_mov_b64 s[72:73], vcc
  v_mov_b32 v77, s30
  v_mov_b32 v79, s31
  s_waitcnt lgkmcnt(4)
  v_max_f32 v29, v108, v110
  v_max3_f32 v29, v29, v112, v114
  v_sub_f32 v108, v108, v29
  v_sub_f32 v110, v110, v29
  v_sub_f32 v112, v112, v29
  v_sub_f32 v114, v114, v29
  v_mul_f32 v108, 0x3fb8aa3b, v108
  v_mul_f32 v110, 0x3fb8aa3b, v110
  v_mul_f32 v112, 0x3fb8aa3b, v112
  v_mul_f32 v114, 0x3fb8aa3b, v114
  v_exp_f32 v108, v108
  v_exp_f32 v110, v110
  v_exp_f32 v112, v112
  v_exp_f32 v114, v114
  v_mul_f32 v30, v109, v108
  v_fmac_f32 v30, v111, v110
  v_fmac_f32 v30, v113, v112
  v_fmac_f32 v30, v115, v114
  s_waitcnt lgkmcnt(0)
  v_mul_f32 v76, v100, v108
  v_mul_f32 v78, v101, v108
  v_fmac_f32 v76, v102, v110
  v_fmac_f32 v78, v103, v110
  v_fmac_f32 v76, v104, v112
  v_fmac_f32 v78, v105, v112
  v_fmac_f32 v76, v106, v114
  v_fmac_f32 v78, v107, v114
  v_cndmask_b32 v76, v76, v29, s[70:71]
  v_cndmask_b32 v78, v78, v30, s[70:71]
  s_mov_b64 exec, s[72:73]
  global_store_dwordx4 v62, v[76:79], s[26:27] sc1
  s_mov_b64 exec, -1
L_nomerge:
  s_cmp_ge_u32 s100, 8
  s_cbranch_scc1 L_diag
  global_load_dwordx4 v[92:95], v64, s[26:27] sc1
  global_load_dwordx4 v[80:83], v63, s[26:27] offset:0 sc1
  global_load_dwordx4 v[84:87], v63, s[26:27] offset:512 sc1
  global_load_dwordx4 v[88:91], v63, s[26:27] offset:1024 sc1
  ds_read_b64_tr_b16 v[208:209], v65 offset:0
  ds_read_b64_tr_b16 v[210:211], v65 offset:1024
  ds_read_b64_tr_b16 v[212:213], v65 offset:8192
  ds_read_b64_tr_b16 v[214:215], v65 offset:9216
  ds_read_b64_tr_b16 v[216:217], v65 offset:16384
  ds_read_b64_tr_b16 v[218:219], v65 offset:17408
  ds_read_b64_tr_b16 v[220:221], v65 offset:24576
  ds_read_b64_tr_b16 v[222:223], v65 offset:25600
  ds_read_b64_tr_b16 v[224:225], v65 offset:32768
  ds_read_b64_tr_b16 v[226:227], v65 offset:33792
  ds_read_b64_tr_b16 v[228:229], v65 offset:40960
  ds_read_b64_tr_b16 v[230:231], v65 offset:41984
  ds_read_b64_tr_b16 v[232:233], v65 offset:32
  ds_read_b64_tr_b16 v[234:235], v65 offset:1056
  ds_read_b64_tr_b16 v[236:237], v65 offset:8224
  ds_read_b64_tr_b16 v[238:239], v65 offset:9248
  ds_read_b64_tr_b16 v[240:241], v65 offset:16416
  ds_read_b64_tr_b16 v[242:243], v65 offset:17440
  ds_read_b64_tr_b16 v[244:245], v65 offset:24608
  ds_read_b64_tr_b16 v[246:247], v65 offset:25632
  ds_read_b64_tr_b16 v[248:249], v65 offset:32800
  ds_read_b64_tr_b16 v[250:251], v65 offset:33824
  ds_read_b64_tr_b16 v[252:253], v65 offset:40992
  ds_read_b64_tr_b16 v[254:255], v65 offset:42016
  ds_read_b32 v19, v71 offset:7040
  s_waitcnt vmcnt(0)
  v_xor_b32 v20, s30, v81
  v_bitop3_b32 v20, v20, v83, s31 bitop3:0xf6
  v_bitop3_b32 v20, v20, v85, s30 bitop3:0xf6
  v_bitop3_b32 v20, v20, v87, s31 bitop3:0xf6
  v_bitop3_b32 v20, v20, v89, s30 bitop3:0xf6
  v_bitop3_b32 v20, v20, v91, s31 bitop3:0xf6
  v_bitop3_b32 v20, v20, v93, s30 bitop3:0xf6
  v_bitop3_b32 v20, v20, v95, s31 bitop3:0xf6
  v_cmp_ne_u32 vcc, 0, v20
  s_cbranch_vccz L_h1ok
L_h1hdr:
  s_add_u32 s74, s74, 1
  s_cmp_gt_u32 s74, 100000
  s_cbranch_scc1 L_end
  s_sleep 2
  global_load_dwordx4 v[92:95], v64, s[26:27] sc1
  global_load_dwordx4 v[80:83], v63, s[26:27] offset:0 sc1
  global_load_dwordx4 v[84:87], v63, s[26:27] offset:512 sc1
  global_load_dwordx4 v[88:91], v63, s[26:27] offset:1024 sc1
  s_waitcnt vmcnt(0)
  v_xor_b32 v20, s30, v81
  v_bitop3_b32 v20, v20, v83, s31 bitop3:0xf6
  v_bitop3_b32 v20, v20, v85, s30 bitop3:0xf6
  v_bitop3_b32 v20, v20, v87, s31 bitop3:0xf6
  v_bitop3_b32 v20, v20, v89, s30 bitop3:0xf6
  v_bitop3_b32 v20, v20, v91, s31 bitop3:0xf6
  v_bitop3_b32 v20, v20, v93, s30 bitop3:0xf6
  v_bitop3_b32 v20, v20, v95, s31 bitop3:0xf6
  v_cmp_ne_u32 vcc, 0, v20
  s_cbranch_vccnz L_h1hdr
L_h1ok:
  v_mov_b32 v20, v92
  v_mov_b32 v21, v92
  s_nop 1
  v_permlane32_swap_b32 v20, v21
  v_max_f32 v20, v20, v21
  v_sub_f32 v21, v92, v20
  v_mul_f32 v21, 0x3fb8aa3b, v21
  v_exp_f32 v21, v21
  s_nop 0
  v_mul_f32 v24, v94, v21
  v_mov_b32 v25, v24
  s_nop 1
  v_permlane32_swap_b32 v24, v25
  v_add_f32 v24, v24, v25
  v_rcp_f32 v24, v24
  s_nop 0
  v_mul_f32 v21, v21, v24
  v_mul_f32 v80, v80, v21
  v_mul_f32 v82, v82, v21
  v_mul_f32 v84, v84, v21
  v_mul_f32 v86, v86, v21
  v_mul_f32 v88, v88, v21
  v_mul_f32 v90, v90, v21
  v_permlane32_swap_b32 v80, v84
  v_permlane32_swap_b32 v82, v86
  v_mov_b32 v24, v88
  v_mov_b32 v25, v90
  v_add_f32 v80, v80, v84
  v_add_f32 v82, v82, v86
  v_permlane32_swap_b32 v88, v24
  v_permlane32_swap_b32 v90, v25
  v_cvt_pk_bf16_f32 v26, v80, v82
  v_add_f32 v88, v88, v24
  v_add_f32 v90, v90, v25
  v_cvt_pk_bf16_f32 v27, v88, v90
  ds_write_b32 v72, v26 offset:10368
  ds_write_b32 v73, v27 offset:10624
  v_and_b32 v8, 16, v1
  v_cmp_ne_u32 s[72:73], 0, v8
  v_mov_b32 v100, 0
  v_mov_b32 v101, 0
  v_mov_b32 v102, 0
  v_mov_b32 v103, 0
  v_mov_b32 v104, 0
  v_mov_b32 v105, 0
  v_mov_b32 v106, 0
  v_mov_b32 v107, 0
  v_mov_b32 v109, s30
  v_mov_b32 v111, s31
  v_mov_b32 v113, s30
  v_mov_b32 v115, s31
  s_waitcnt lgkmcnt(0)
  s_barrier
  ds_read_b128 v[136:139], v74 offset:10368
  ds_read_b128 v[140:143], v74 offset:10432
  ds_read_b128 v[144:147], v74 offset:10496
  ds_read_b128 v[148:151], v74 offset:10560
  ds_read_b128 v[152:155], v74 offset:10624
  ds_read_b128 v[156:159], v74 offset:10688
  s_waitcnt lgkmcnt(4)
  v_mfma_f32_16x16x32_bf16 v[100:103], v[136:139], v[208:211], v[100:103]
  v_mfma_f32_16x16x32_bf16 v[104:107], v[136:139], v[232:235], v[104:107]
  v_mfma_f32_16x16x32_bf16 v[100:103], v[140:143], v[212:215], v[100:103]
  v_mfma_f32_16x16x32_bf16 v[104:107], v[140:143], v[236:239], v[104:107]
  s_waitcnt lgkmcnt(2)
  v_mfma_f32_16x16x32_bf16 v[100:103], v[144:147], v[216:219], v[100:103]
  v_mfma_f32_16x16x32_bf16 v[104:107], v[144:147], v[240:243], v[104:107]
  v_mfma_f32_16x16x32_bf16 v[100:103], v[148:151], v[220:223], v[100:103]
  v_mfma_f32_16x16x32_bf16 v[104:107], v[148:151], v[244:247], v[104:107]
  s_waitcnt lgkmcnt(0)
  v_mfma_f32_16x16x32_bf16 v[100:103], v[152:155], v[224:227], v[100:103]
  v_mfma_f32_16x16x32_bf16 v[104:107], v[152:155], v[248:251], v[104:107]
  v_mfma_f32_16x16x32_bf16 v[100:103], v[156:159], v[228:231], v[100:103]
  v_mfma_f32_16x16x32_bf16 v[104:107], v[156:159], v[252:255], v[104:107]
  s_nop 6
  v_cndmask_b32 v108, v100, v102, s[72:73]
  v_cndmask_b32 v110, v101, v103, s[72:73]
  v_cndmask_b32 v112, v104, v106, s[72:73]
  v_cndmask_b32 v114, v105, v107, s[72:73]
  s_mov_b32 exec_hi, 0
  global_store_dwordx4 v66, v[108:111], s[26:27] sc1
  global_store_dwordx4 v67, v[112:115], s[26:27] sc1
  s_mov_b32 exec_hi, -1
  s_cmp_lg_u32 s3, 0
  s_cbranch_scc1 L_fin_end
L_spoll:
  global_load_dwordx4 v[80:83], v68, s[26:27] offset:0 sc1
  global_load_dwordx4 v[84:87], v68, s[26:27] offset:1024 sc1
  global_load_dwordx4 v[88:91], v68, s[26:27] offset:2048 sc1
  global_load_dwordx4 v[92:95], v68, s[26:27] offset:3072 sc1
  s_waitcnt vmcnt(0)
  v_xor_b32 v20, s30, v81
  v_bitop3_b32 v20, v20, v83, s31 bitop3:0xf6
  v_bitop3_b32 v20, v20, v85, s30 bitop3:0xf6
  v_bitop3_b32 v20, v20, v87, s31 bitop3:0xf6
  v_bitop3_b32 v20, v20, v89, s30 bitop3:0xf6
  v_bitop3_b32 v20, v20, v91, s31 bitop3:0xf6
  v_bitop3_b32 v20, v20, v93, s30 bitop3:0xf6
  v_bitop3_b32 v20, v20, v95, s31 bitop3:0xf6
  v_cmp_ne_u32 vcc, 0, v20
  s_cbranch_vccz L_sok
  s_add_u32 s74, s74, 1
  s_cmp_gt_u32 s74, 100000
  s_cbranch_scc1 L_end
  s_sleep 2
  s_branch L_spoll
L_sok:
  v_add_f32 v80, v80, v84
  v_add_f32 v82, v82, v86
  v_add_f32 v80, v80, v88
  v_add_f32 v82, v82, v90
  v_add_f32 v80, v80, v92
  v_add_f32 v82, v82, v94
  s_nop 0
  v_add_f32 v80, v80, v80 row_ror:8 row_mask:0xf bank_mask:0xf
  v_add_f32 v82, v82, v82 row_ror:8 row_mask:0xf bank_mask:0xf
  v_mov_b32 v20, v80
  v_mov_b32 v21, v82
  s_nop 0
  v_permlane16_swap_b32 v80, v20
  v_permlane16_swap_b32 v82, v21
  v_add_f32 v80, v80, v20
  v_add_f32 v82, v82, v21
  v_mov_b32 v20, v80
  v_mov_b32 v21, v82
  s_nop 0
  v_permlane32_swap_b32 v80, v20
  v_permlane32_swap_b32 v82, v21
  v_add_f32 v80, v80, v20
  v_add_f32 v82, v82, v21
  v_and_b32 v20, 8, v1
  v_cmp_ne_u32 vcc, 0, v20
  s_nop 1
  v_cndmask_b32 v21, v80, v82, vcc
  v_cvt_pk_bf16_f32 v21, v21, v21
  v_lshlrev_b32 v21, 16, v21
  v_mul_f32 v21, v21, v19
  v_cvt_pk_bf16_f32 v21, v21, v21
  v_lshlrev_b32 v21, 16, v21
  v_lshlrev_b32 v22, 16, v70
  v_add_f32 v21, v21, v22
  v_cvt_pk_bf16_f32 v21, v21, v21
  s_mov_b64 exec, 0xffff
  global_store_short v69, v21, s[22:23]
  s_mov_b64 exec, -1
  s_add_u32 s64, s56, s100
  s_cmp_lg_u32 s64, 0
  s_cbranch_scc1 L_fin_end
  v_mov_b32 v22, s30
  v_mov_b32 v23, s31
  v_mov_b32 v24, 0
  s_mov_b64 exec, 1
  global_store_dwordx2 v24, v[22:23], s[26:27] sc1
  s_mov_b64 exec, -1
L_fin_end:
  s_branch L_diag
L_svc:
  s_mov_b32 s101, 0
  v_lshlrev_b32 v3, 11, v4
  v_lshl_add_u32 v3, v5, 4, v3
  s_mul_i32 s64, s56, 12288
  s_lshl_b32 s65, s58, 9
  s_add_u32 s64, s64, s65
  s_add_u32 s64, s64, 1048576
  v_add_u32 v8, s64, v3
  v_add_u32 v9, 4096, v8
  v_add_u32 v10, 8192, v8
  v_lshlrev_b32 v11, 2, v5
  s_waitcnt lgkmcnt(0)
  s_load_dwordx2 s[28:29], s[26:27], 0
  s_mov_b32 s48, s16
  s_mov_b32 s49, s17
  s_mov_b32 s50, 1966080
  s_mov_b32 s51, 0x20000
  s_mov_b32 s52, s18
  s_mov_b32 s53, s19
  s_mov_b32 s54, 1966080
  s_mov_b32 s55, 0x20000
  s_mov_b32 s76, s20
  s_mov_b32 s77, s21
  s_mov_b32 s78, 1966080
  s_mov_b32 s79, 0x20000
  s_waitcnt lgkmcnt(0)
  s_add_u32 s30, s28, 1
  s_add_u32 s31, s29, 1
  s_barrier
  s_lshl_b32 s64, s56, 3
  s_add_u32 s65, s64, s60
  s_lshl_b32 s65, s65, 4
  s_add_u32 s65, s65, 3538944
  v_mov_b32 v12, s65
  v_mov_b32 v40, 0
  v_mov_b32 v41, s30
  v_mov_b32 v42, 0
  v_mov_b32 v43, s31
  s_mov_b64 exec, 1
  global_store_dwordx4 v12, v[40:43], s[26:27] sc1
  s_mov_b64 exec, -1
  s_xor_b32 s65, s60, 1
  s_add_u32 s65, s65, s64
  s_lshl_b32 s65, s65, 4
  s_add_u32 s65, s65, 3538944
  v_mov_b32 v12, s65
L_qpoll:
  global_load_dwordx4 v[16:19], v8, s[26:27] sc1
  global_load_dwordx4 v[20:23], v9, s[26:27] sc1
  global_load_dwordx4 v[24:27], v10, s[26:27] sc1
  global_load_dwordx4 v[28:31], v12, s[26:27] sc1
  s_waitcnt vmcnt(0)
  v_xor_b32 v34, s30, v17
  v_bitop3_b32 v34, v34, v19, s31 bitop3:0xf6
  v_bitop3_b32 v34, v34, v21, s30 bitop3:0xf6
  v_bitop3_b32 v34, v34, v23, s31 bitop3:0xf6
  v_bitop3_b32 v34, v34, v25, s30 bitop3:0xf6
  v_bitop3_b32 v34, v34, v27, s31 bitop3:0xf6
  v_bitop3_b32 v34, v34, v29, s30 bitop3:0xf6
  v_bitop3_b32 v34, v34, v31, s31 bitop3:0xf6
  v_cmp_ne_u32 vcc, 0, v34
  s_cbranch_vccz L_qgot
  s_add_u32 s74, s74, 1
  s_cmp_gt_u32 s74, 100000
  s_cbranch_scc1 L_end
  s_branch L_qpoll
L_qgot:
  v_mov_b32 v34, v16
  v_mov_b32 v35, v18
  v_mov_b32 v36, v20
  v_mov_b32 v37, v22
  v_mov_b32 v38, v24
  v_mov_b32 v39, v26
  v_permlane32_swap_b32 v16, v34
  v_permlane32_swap_b32 v18, v35
  v_permlane32_swap_b32 v20, v36
  v_permlane32_swap_b32 v22, v37
  v_permlane32_swap_b32 v24, v38
  v_permlane32_swap_b32 v26, v39
  v_add_f32 v16, v16, v34
  v_add_f32 v18, v18, v35
  v_add_f32 v20, v20, v36
  v_add_f32 v22, v22, v37
  v_add_f32 v24, v24, v38
  v_add_f32 v26, v26, v39
  v_cvt_pk_bf16_f32 v34, v16, v18
  v_cvt_pk_bf16_f32 v35, v20, v22
  v_cvt_pk_bf16_f32 v36, v24, v26
  ds_write_b32 v11, v34 offset:5376
  ds_write_b32 v11, v35 offset:5504
  ds_write_b32 v11, v36 offset:5632
  s_waitcnt lgkmcnt(0)
  s_barrier
  s_waitcnt vmcnt(0)
  s_cmp_lt_u32 s100, 8
  s_cbranch_scc1 L_nof1
  s_mul_i32 s63, s56, 3
  s_add_u32 s63, s63, s58
  s_lshr_b32 s61, s63, 2
  s_and_b32 s62, s63, 3
  v_lshrrev_b32 v3, 4, v1
  v_and_b32 v13, 3, v1
  v_bfe_u32 v14, v1, 2, 2
  v_mul_u32_u24 v10, 1344, v13
  v_lshl_add_u32 v10, v3, 4, v10
  s_mul_i32 s64, s62, 320
  v_add_u32 v10, s64, v10
  v_lshl_add_u32 v15, v3, 3, v14
  v_lshlrev_b32 v15, 7, v15
  v_lshl_add_u32 v11, v13, 3, v15
  v_add_u32 v11, 53504, v11
  ds_read_b128 v[16:19], v10 offset:0
  ds_read_b128 v[20:23], v10 offset:64
  ds_read_b128 v[24:27], v10 offset:128
  ds_read_b128 v[28:31], v10 offset:192
  ds_read_b128 v[32:35], v10 offset:256
  v_mov_b32 v120, 0
  v_mov_b32 v121, 0
  v_mov_b32 v122, 0
  v_mov_b32 v123, 0
  v_mov_b32 v124, 0
  v_mov_b32 v125, 0
  v_mov_b32 v126, 0
  v_mov_b32 v127, 0
  v_mov_b32 v128, 0
  v_mov_b32 v129, 0
  v_mov_b32 v130, 0
  v_mov_b32 v131, 0
  v_mov_b32 v132, 0
  v_mov_b32 v133, 0
  v_mov_b32 v134, 0
  v_mov_b32 v135, 0
  v_mov_b32 v136, 0
  v_mov_b32 v137, 0
  v_mov_b32 v138, 0
  v_mov_b32 v139, 0
  v_mov_b32 v140, 0
  v_mov_b32 v141, 0
  v_mov_b32 v142, 0
  v_mov_b32 v143, 0
  v_mov_b32 v144, 0
  v_mov_b32 v145, 0
  v_mov_b32 v146, 0
  v_mov_b32 v147, 0
  v_mov_b32 v148, 0
  v_mov_b32 v149, 0
  v_mov_b32 v150, 0
  v_mov_b32 v151, 0
  v_cmp_eq_u32 s[72:73], 1, v3
  v_cmp_eq_u32 s[70:71], 2, v3
  v_cmp_eq_u32 s[24:25], 3, v3
  ds_read_b64_tr_b16 v[40:41], v11 offset:0
  ds_read_b64_tr_b16 v[42:43], v11 offset:512
  ds_read_b64_tr_b16 v[44:45], v11 offset:4096
  ds_read_b64_tr_b16 v[46:47], v11 offset:4608
  ds_read_b64_tr_b16 v[48:49], v11 offset:8192
  ds_read_b64_tr_b16 v[50:51], v11 offset:8704
  ds_read_b64_tr_b16 v[52:53], v11 offset:12288
  ds_read_b64_tr_b16 v[54:55], v11 offset:12800
  ds_read_b64_tr_b16 v[56:57], v11 offset:16384
  ds_read_b64_tr_b16 v[58:59], v11 offset:16896
  s_waitcnt lgkmcnt(0)
  ds_read_b64_tr_b16 v[60:61], v11 offset:32
  ds_read_b64_tr_b16 v[62:63], v11 offset:544
  ds_read_b64_tr_b16 v[64:65], v11 offset:4128
  ds_read_b64_tr_b16 v[66:67], v11 offset:4640
  ds_read_b64_tr_b16 v[68:69], v11 offset:8224
  ds_read_b64_tr_b16 v[70:71], v11 offset:8736
  ds_read_b64_tr_b16 v[72:73], v11 offset:12320
  ds_read_b64_tr_b16 v[74:75], v11 offset:12832
  ds_read_b64_tr_b16 v[76:77], v11 offset:16416
  ds_read_b64_tr_b16 v[78:79], v11 offset:16928
  s_waitcnt lgkmcnt(0)
  ds_read_b64_tr_b16 v[80:81], v11 offset:64
  ds_read_b64_tr_b16 v[82:83], v11 offset:576
  ds_read_b64_tr_b16 v[84:85], v11 offset:4160
  ds_read_b64_tr_b16 v[86:87], v11 offset:4672
  ds_read_b64_tr_b16 v[88:89], v11 offset:8256
  ds_read_b64_tr_b16 v[90:91], v11 offset:8768
  ds_read_b64_tr_b16 v[92:93], v11 offset:12352
  ds_read_b64_tr_b16 v[94:95], v11 offset:12864
  ds_read_b64_tr_b16 v[96:97], v11 offset:16448
  ds_read_b64_tr_b16 v[98:99], v11 offset:16960
  s_waitcnt lgkmcnt(0)
  ds_read_b64_tr_b16 v[100:101], v11 offset:96
  ds_read_b64_tr_b16 v[102:103], v11 offset:608
  ds_read_b64_tr_b16 v[104:105], v11 offset:4192
  ds_read_b64_tr_b16 v[106:107], v11 offset:4704
  ds_read_b64_tr_b16 v[108:109], v11 offset:8288
  ds_read_b64_tr_b16 v[110:111], v11 offset:8800
  ds_read_b64_tr_b16 v[112:113], v11 offset:12384
  ds_read_b64_tr_b16 v[114:115], v11 offset:12896
  ds_read_b64_tr_b16 v[116:117], v11 offset:16480
  ds_read_b64_tr_b16 v[118:119], v11 offset:16992
  s_waitcnt lgkmcnt(0)
  v_mfma_f32_16x16x32_bf16 v[120:123], v[16:19], v[40:43], v[120:123]
  v_mfma_f32_16x16x32_bf16 v[124:127], v[16:19], v[60:63], v[124:127]
  v_mfma_f32_16x16x32_bf16 v[128:131], v[16:19], v[80:83], v[128:131]
  v_mfma_f32_16x16x32_bf16 v[132:135], v[16:19], v[100:103], v[132:135]
  v_mfma_f32_16x16x32_bf16 v[120:123], v[20:23], v[44:47], v[120:123]
  v_mfma_f32_16x16x32_bf16 v[124:127], v[20:23], v[64:67], v[124:127]
  v_mfma_f32_16x16x32_bf16 v[128:131], v[20:23], v[84:87], v[128:131]
  v_mfma_f32_16x16x32_bf16 v[132:135], v[20:23], v[104:107], v[132:135]
  v_mfma_f32_16x16x32_bf16 v[120:123], v[24:27], v[48:51], v[120:123]
  v_mfma_f32_16x16x32_bf16 v[124:127], v[24:27], v[68:71], v[124:127]
  v_mfma_f32_16x16x32_bf16 v[128:131], v[24:27], v[88:91], v[128:131]
  v_mfma_f32_16x16x32_bf16 v[132:135], v[24:27], v[108:111], v[132:135]
  v_mfma_f32_16x16x32_bf16 v[120:123], v[28:31], v[52:55], v[120:123]
  v_mfma_f32_16x16x32_bf16 v[124:127], v[28:31], v[72:75], v[124:127]
  v_mfma_f32_16x16x32_bf16 v[128:131], v[28:31], v[92:95], v[128:131]
  v_mfma_f32_16x16x32_bf16 v[132:135], v[28:31], v[112:115], v[132:135]
  v_mfma_f32_16x16x32_bf16 v[120:123], v[32:35], v[56:59], v[120:123]
  v_mfma_f32_16x16x32_bf16 v[124:127], v[32:35], v[76:79], v[124:127]
  v_mfma_f32_16x16x32_bf16 v[128:131], v[32:35], v[96:99], v[128:131]
  v_mfma_f32_16x16x32_bf16 v[132:135], v[32:35], v[116:119], v[132:135]
  ds_read_b64_tr_b16 v[40:41], v11 offset:20480
  ds_read_b64_tr_b16 v[42:43], v11 offset:20992
  ds_read_b64_tr_b16 v[44:45], v11 offset:24576
  ds_read_b64_tr_b16 v[46:47], v11 offset:25088
  ds_read_b64_tr_b16 v[48:49], v11 offset:28672
  ds_read_b64_tr_b16 v[50:51], v11 offset:29184
  ds_read_b64_tr_b16 v[52:53], v11 offset:32768
  ds_read_b64_tr_b16 v[54:55], v11 offset:33280
  ds_read_b64_tr_b16 v[56:57], v11 offset:36864
  ds_read_b64_tr_b16 v[58:59], v11 offset:37376
  s_waitcnt lgkmcnt(0)
  ds_read_b64_tr_b16 v[60:61], v11 offset:20512
  ds_read_b64_tr_b16 v[62:63], v11 offset:21024
  ds_read_b64_tr_b16 v[64:65], v11 offset:24608
  ds_read_b64_tr_b16 v[66:67], v11 offset:25120
  ds_read_b64_tr_b16 v[68:69], v11 offset:28704
  ds_read_b64_tr_b16 v[70:71], v11 offset:29216
  ds_read_b64_tr_b16 v[72:73], v11 offset:32800
  ds_read_b64_tr_b16 v[74:75], v11 offset:33312
  ds_read_b64_tr_b16 v[76:77], v11 offset:36896
  ds_read_b64_tr_b16 v[78:79], v11 offset:37408
  s_waitcnt lgkmcnt(0)
  ds_read_b64_tr_b16 v[80:81], v11 offset:20544
  ds_read_b64_tr_b16 v[82:83], v11 offset:21056
  ds_read_b64_tr_b16 v[84:85], v11 offset:24640
  ds_read_b64_tr_b16 v[86:87], v11 offset:25152
  ds_read_b64_tr_b16 v[88:89], v11 offset:28736
  ds_read_b64_tr_b16 v[90:91], v11 offset:29248
  ds_read_b64_tr_b16 v[92:93], v11 offset:32832
  ds_read_b64_tr_b16 v[94:95], v11 offset:33344
  ds_read_b64_tr_b16 v[96:97], v11 offset:36928
  ds_read_b64_tr_b16 v[98:99], v11 offset:37440
  s_waitcnt lgkmcnt(0)
  ds_read_b64_tr_b16 v[100:101], v11 offset:20576
  ds_read_b64_tr_b16 v[102:103], v11 offset:21088
  ds_read_b64_tr_b16 v[104:105], v11 offset:24672
  ds_read_b64_tr_b16 v[106:107], v11 offset:25184
  ds_read_b64_tr_b16 v[108:109], v11 offset:28768
  ds_read_b64_tr_b16 v[110:111], v11 offset:29280
  ds_read_b64_tr_b16 v[112:113], v11 offset:32864
  ds_read_b64_tr_b16 v[114:115], v11 offset:33376
  ds_read_b64_tr_b16 v[116:117], v11 offset:36960
  ds_read_b64_tr_b16 v[118:119], v11 offset:37472
  s_waitcnt lgkmcnt(0)
  v_mfma_f32_16x16x32_bf16 v[136:139], v[16:19], v[40:43], v[136:139]
  v_mfma_f32_16x16x32_bf16 v[140:143], v[16:19], v[60:63], v[140:143]
  v_mfma_f32_16x16x32_bf16 v[144:147], v[16:19], v[80:83], v[144:147]
  v_mfma_f32_16x16x32_bf16 v[148:151], v[16:19], v[100:103], v[148:151]
  v_mfma_f32_16x16x32_bf16 v[136:139], v[20:23], v[44:47], v[136:139]
  v_mfma_f32_16x16x32_bf16 v[140:143], v[20:23], v[64:67], v[140:143]
  v_mfma_f32_16x16x32_bf16 v[144:147], v[20:23], v[84:87], v[144:147]
  v_mfma_f32_16x16x32_bf16 v[148:151], v[20:23], v[104:107], v[148:151]
  v_mfma_f32_16x16x32_bf16 v[136:139], v[24:27], v[48:51], v[136:139]
  v_mfma_f32_16x16x32_bf16 v[140:143], v[24:27], v[68:71], v[140:143]
  v_mfma_f32_16x16x32_bf16 v[144:147], v[24:27], v[88:91], v[144:147]
  v_mfma_f32_16x16x32_bf16 v[148:151], v[24:27], v[108:111], v[148:151]
  v_mfma_f32_16x16x32_bf16 v[136:139], v[28:31], v[52:55], v[136:139]
  v_mfma_f32_16x16x32_bf16 v[140:143], v[28:31], v[72:75], v[140:143]
  v_mfma_f32_16x16x32_bf16 v[144:147], v[28:31], v[92:95], v[144:147]
  v_mfma_f32_16x16x32_bf16 v[148:151], v[28:31], v[112:115], v[148:151]
  v_mfma_f32_16x16x32_bf16 v[136:139], v[32:35], v[56:59], v[136:139]
  v_mfma_f32_16x16x32_bf16 v[140:143], v[32:35], v[76:79], v[140:143]
  v_mfma_f32_16x16x32_bf16 v[144:147], v[32:35], v[96:99], v[144:147]
  v_mfma_f32_16x16x32_bf16 v[148:151], v[32:35], v[116:119], v[148:151]
  s_lshl_b32 s64, s63, 11
  s_add_u32 s64, s64, 2752512
  v_lshl_add_u32 v13, v1, 4, s64
  v_cndmask_b32 v32, v120, v124, s[72:73]
  v_cndmask_b32 v32, v32, v128, s[70:71]
  v_cndmask_b32 v32, v32, v132, s[24:25]
  v_cndmask_b32 v33, v121, v125, s[72:73]
  v_cndmask_b32 v33, v33, v129, s[70:71]
  v_cndmask_b32 v33, v33, v133, s[24:25]
  v_cndmask_b32 v34, v122, v126, s[72:73]
  v_cndmask_b32 v34, v34, v130, s[70:71]
  v_cndmask_b32 v34, v34, v134, s[24:25]
  v_cndmask_b32 v35, v123, v127, s[72:73]
  v_cndmask_b32 v35, v35, v131, s[70:71]
  v_cndmask_b32 v35, v35, v135, s[24:25]
  global_store_dwordx4 v13, v[32:35], s[26:27] offset:0 sc1 nt
  v_cndmask_b32 v36, v136, v140, s[72:73]
  v_cndmask_b32 v36, v36, v144, s[70:71]
  v_cndmask_b32 v36, v36, v148, s[24:25]
  v_cndmask_b32 v37, v137, v141, s[72:73]
  v_cndmask_b32 v37, v37, v145, s[70:71]
  v_cndmask_b32 v37, v37, v149, s[24:25]
  v_cndmask_b32 v38, v138, v142, s[72:73]
  v_cndmask_b32 v38, v38, v146, s[70:71]
  v_cndmask_b32 v38, v38, v150, s[24:25]
  v_cndmask_b32 v39, v139, v143, s[72:73]
  v_cndmask_b32 v39, v39, v147, s[70:71]
  v_cndmask_b32 v39, v39, v151, s[24:25]
  global_store_dwordx4 v13, v[36:39], s[26:27] offset:1024 sc1 nt
  s_lshl_b32 s64, s63, 4
  s_add_u32 s64, s64, 3145728
  v_mov_b32 v14, s64
  v_mov_b32 v40, 0
  v_mov_b32 v41, s30
  v_mov_b32 v42, 0
  v_mov_b32 v43, s31
  s_waitcnt vmcnt(0)
  s_mov_b64 exec, 1
  global_store_dwordx4 v14, v[40:43], s[26:27] sc1
  s_mov_b64 exec, -1
  s_lshl_b32 s64, s61, 6
  s_add_u32 s64, s64, 3145728
  v_and_b32 v15, 3, v1
  v_lshl_add_u32 v15, v15, 4, s64
L_f1poll:
  global_load_dwordx4 v[44:47], v15, s[26:27] sc1
  s_waitcnt vmcnt(0)
  v_xor_b32 v64, s30, v45
  v_bitop3_b32 v64, v64, v47, s31 bitop3:0xf6
  v_cmp_ne_u32 vcc, 0, v64
  s_cbranch_vccz L_f1ok
  s_add_u32 s74, s74, 1
  s_cmp_gt_u32 s74, 100000
  s_cbranch_scc1 L_end
  s_sleep 32
  s_branch L_f1poll
L_f1ok:
  s_lshl_b32 s64, s61, 13
  s_lshl_b32 s65, s62, 8
  s_add_u32 s64, s64, s65
  s_add_u32 s64, s64, 2752512
  v_lshrrev_b32 v3, 4, v1
  v_lshlrev_b32 v14, 11, v3
  v_and_b32 v15, 15, v1
  v_lshl_add_u32 v14, v15, 4, v14
  v_add_u32 v14, s64, v14
  global_load_dwordx4 v[48:51], v14, s[26:27] offset:0 sc1 nt
  global_load_dwordx4 v[52:55], v14, s[26:27] offset:1024 sc1 nt
  s_waitcnt vmcnt(0)
  v_mov_b32 v64, v48
  v_mov_b32 v65, v49
  v_mov_b32 v66, v50
  v_mov_b32 v67, v51
  v_mov_b32 v68, v52
  v_mov_b32 v69, v53
  v_mov_b32 v70, v54
  v_mov_b32 v71, v55
  v_permlane16_swap_b32 v48, v64
  v_permlane16_swap_b32 v49, v65
  v_permlane16_swap_b32 v50, v66
  v_permlane16_swap_b32 v51, v67
  v_permlane16_swap_b32 v52, v68
  v_permlane16_swap_b32 v53, v69
  v_permlane16_swap_b32 v54, v70
  v_permlane16_swap_b32 v55, v71
  v_add_f32 v48, v48, v64
  v_add_f32 v49, v49, v65
  v_add_f32 v50, v50, v66
  v_add_f32 v51, v51, v67
  v_add_f32 v52, v52, v68
  v_add_f32 v53, v53, v69
  v_add_f32 v54, v54, v70
  v_add_f32 v55, v55, v71
  v_mov_b32 v64, v48
  v_mov_b32 v65, v49
  v_mov_b32 v66, v50
  v_mov_b32 v67, v51
  v_mov_b32 v68, v52
  v_mov_b32 v69, v53
  v_mov_b32 v70, v54
  v_mov_b32 v71, v55
  v_permlane32_swap_b32 v48, v64
  v_permlane32_swap_b32 v49, v65
  v_permlane32_swap_b32 v50, v66
  v_permlane32_swap_b32 v51, v67
  v_permlane32_swap_b32 v52, v68
  v_permlane32_swap_b32 v53, v69
  v_permlane32_swap_b32 v54, v70
  v_permlane32_swap_b32 v55, v71
  v_add_f32 v48, v48, v64
  v_add_f32 v49, v49, v65
  v_add_f32 v50, v50, v66
  v_add_f32 v51, v51, v67
  v_add_f32 v52, v52, v68
  v_add_f32 v53, v53, v69
  v_add_f32 v54, v54, v70
  v_add_f32 v55, v55, v71
  v_cndmask_b32 v72, v48, v49, s[72:73]
  v_cndmask_b32 v72, v72, v50, s[70:71]
  v_cndmask_b32 v72, v72, v51, s[24:25]
  v_cndmask_b32 v73, v52, v53, s[72:73]
  v_cndmask_b32 v73, v73, v54, s[70:71]
  v_cndmask_b32 v73, v73, v55, s[24:25]
  v_cvt_pk_bf16_f32 v72, v72, v72
  v_lshlrev_b32 v72, 16, v72
  v_cvt_pk_bf16_f32 v73, v73, v73
  v_lshlrev_b32 v73, 16, v73
  v_mul_f32 v74, v72, v72
  v_mul_f32 v74, v74, v72
  v_mul_f32 v74, 0x3d372713, v74
  v_add_f32 v74, v72, v74
  v_mul_f32 v74, 0xc0135761, v74
  v_exp_f32 v74, v74
  s_nop 0
  v_add_f32 v74, 1.0, v74
  v_rcp_f32 v74, v74
  s_nop 0
  v_mul_f32 v74, v72, v74
  v_cvt_pk_bf16_f32 v74, v74, v74
  v_lshlrev_b32 v74, 16, v74
  v_mul_f32 v74, v74, v73
  v_cvt_pk_bf16_f32 v74, v74, v74
  s_nop 1
  v_mov_b32 v75, v74 quad_perm:[1,0,3,2] row_mask:0xf bank_mask:0xf
  v_perm_b32 v76, v75, v74, s68
  v_mov_b32 v78, v76
  s_nop 1
  v_permlane16_swap_b32 v76, v78
  v_mov_b32 v77, s30
  v_mov_b32 v79, s31
  s_lshl_b32 s64, s63, 8
  s_add_u32 s64, s64, 3149824
  v_lshlrev_b32 v3, 7, v4
  v_lshl_add_u32 v3, v15, 3, v3
  v_add_u32 v3, s64, v3
  s_mov_b32 exec_lo, 0x00005555
  s_mov_b32 exec_hi, 0x00005555
  global_store_dwordx4 v3, v[76:79], s[26:27] sc1
  s_mov_b64 exec, -1
  s_branch L_diag
L_nof1:
  s_cmp_lt_u32 s60, 6
  s_cbranch_scc1 L_nof2
  s_lshl_b32 s63, s56, 1
  s_add_u32 s63, s63, s59
  s_cmp_ge_u32 s63, 60
  s_cbranch_scc1 L_nof2
  s_mul_i32 s61, s63, 52
  s_lshr_b32 s61, s61, 8
  s_mul_i32 s62, s61, 5
  s_sub_u32 s62, s63, s62
  s_lshl_b32 s64, s61, 11
  s_add_u32 s64, s64, 3149824
  v_lshl_add_u32 v14, v1, 4, s64
  v_lshrrev_b32 v3, 4, v1
  v_bfe_u32 v15, v1, 2, 2
  v_lshl_add_u32 v15, v3, 3, v15
  v_lshlrev_b32 v15, 8, v15
  v_and_b32 v13, 3, v1
  v_lshl_add_u32 v12, v13, 3, v15
  v_add_u32 v12, 12544, v12
L_f2poll:
  global_load_dwordx4 v[48:51], v14, s[26:27] sc1
  global_load_dwordx4 v[52:55], v14, s[26:27] offset:1024 sc1
  s_waitcnt vmcnt(0)
  v_xor_b32 v64, s30, v49
  v_bitop3_b32 v64, v64, v51, s31 bitop3:0xf6
  v_bitop3_b32 v64, v64, v53, s30 bitop3:0xf6
  v_bitop3_b32 v64, v64, v55, s31 bitop3:0xf6
  v_cmp_ne_u32 vcc, 0, v64
  s_cbranch_vccz L_f2ok
  s_add_u32 s74, s74, 1
  s_cmp_gt_u32 s74, 100000
  s_cbranch_scc1 L_end
  s_sleep 32
  s_branch L_f2poll
L_f2ok:
  v_and_b32 v3, 1, v6
  v_mul_u32_u24 v3, 640, v3
  v_lshrrev_b32 v14, 4, v1
  v_lshl_add_u32 v3, v14, 5, v3
  v_lshl_add_u32 v3, v7, 2, v3
  ds_write_b32 v3, v48 offset:5760
  ds_write_b32 v3, v50 offset:6080
  ds_write_b32 v3, v52 offset:5888
  ds_write_b32 v3, v54 offset:6208
  v_mul_u32_u24 v3, 320, v13
  v_lshl_add_u32 v3, v14, 4, v3
  s_waitcnt lgkmcnt(0)
  ds_read_b128 v[48:51], v3 offset:5760
  ds_read_b128 v[52:55], v3 offset:5824
  ds_read_b128 v[56:59], v3 offset:5888
  ds_read_b128 v[60:63], v3 offset:5952
  v_mov_b32 v144, 0
  v_mov_b32 v145, 0
  v_mov_b32 v146, 0
  v_mov_b32 v147, 0
  v_mov_b32 v148, 0
  v_mov_b32 v149, 0
  v_mov_b32 v150, 0
  v_mov_b32 v151, 0
  v_mov_b32 v152, 0
  v_mov_b32 v153, 0
  v_mov_b32 v154, 0
  v_mov_b32 v155, 0
  v_mov_b32 v156, 0
  v_mov_b32 v157, 0
  v_mov_b32 v158, 0
  v_mov_b32 v159, 0
  v_mov_b32 v160, 0
  v_mov_b32 v161, 0
  v_mov_b32 v162, 0
  v_mov_b32 v163, 0
  v_mov_b32 v164, 0
  v_mov_b32 v165, 0
  v_mov_b32 v166, 0
  v_mov_b32 v167, 0
  v_mov_b32 v168, 0
  v_mov_b32 v169, 0
  v_mov_b32 v170, 0
  v_mov_b32 v171, 0
  v_mov_b32 v172, 0
  v_mov_b32 v173, 0
  v_mov_b32 v174, 0
  v_mov_b32 v175, 0
  v_cmp_eq_u32 s[72:73], 1, v14
  v_cmp_eq_u32 s[70:71], 2, v14
  v_cmp_eq_u32 s[24:25], 3, v14
  s_mul_i32 s63, s62, 12
  s_add_u32 s63, s63, s61
  s_lshl_b32 s64, s63, 11
  s_add_u32 s64, s64, 3178496
  v_lshl_add_u32 v13, v1, 4, s64
  ds_read_b64_tr_b16 v[80:81], v12 offset:0
  ds_read_b64_tr_b16 v[82:83], v12 offset:1024
  ds_read_b64_tr_b16 v[84:85], v12 offset:8192
  ds_read_b64_tr_b16 v[86:87], v12 offset:9216
  ds_read_b64_tr_b16 v[88:89], v12 offset:32
  ds_read_b64_tr_b16 v[90:91], v12 offset:1056
  ds_read_b64_tr_b16 v[92:93], v12 offset:8224
  ds_read_b64_tr_b16 v[94:95], v12 offset:9248
  s_waitcnt lgkmcnt(0)
  ds_read_b64_tr_b16 v[96:97], v12 offset:64
  ds_read_b64_tr_b16 v[98:99], v12 offset:1088
  ds_read_b64_tr_b16 v[100:101], v12 offset:8256
  ds_read_b64_tr_b16 v[102:103], v12 offset:9280
  ds_read_b64_tr_b16 v[104:105], v12 offset:96
  ds_read_b64_tr_b16 v[106:107], v12 offset:1120
  ds_read_b64_tr_b16 v[108:109], v12 offset:8288
  ds_read_b64_tr_b16 v[110:111], v12 offset:9312
  s_waitcnt lgkmcnt(0)
  ds_read_b64_tr_b16 v[112:113], v12 offset:128
  ds_read_b64_tr_b16 v[114:115], v12 offset:1152
  ds_read_b64_tr_b16 v[116:117], v12 offset:8320
  ds_read_b64_tr_b16 v[118:119], v12 offset:9344
  ds_read_b64_tr_b16 v[120:121], v12 offset:160
  ds_read_b64_tr_b16 v[122:123], v12 offset:1184
  ds_read_b64_tr_b16 v[124:125], v12 offset:8352
  ds_read_b64_tr_b16 v[126:127], v12 offset:9376
  s_waitcnt lgkmcnt(0)
  ds_read_b64_tr_b16 v[128:129], v12 offset:192
  ds_read_b64_tr_b16 v[130:131], v12 offset:1216
  ds_read_b64_tr_b16 v[132:133], v12 offset:8384
  ds_read_b64_tr_b16 v[134:135], v12 offset:9408
  ds_read_b64_tr_b16 v[136:137], v12 offset:224
  ds_read_b64_tr_b16 v[138:139], v12 offset:1248
  ds_read_b64_tr_b16 v[140:141], v12 offset:8416
  ds_read_b64_tr_b16 v[142:143], v12 offset:9440
  s_waitcnt lgkmcnt(0)
  v_mfma_f32_16x16x32_bf16 v[144:147], v[48:51], v[80:83], v[144:147]
  v_mfma_f32_16x16x32_bf16 v[148:151], v[48:51], v[88:91], v[148:151]
  v_mfma_f32_16x16x32_bf16 v[152:155], v[48:51], v[96:99], v[152:155]
  v_mfma_f32_16x16x32_bf16 v[156:159], v[48:51], v[104:107], v[156:159]
  v_mfma_f32_16x16x32_bf16 v[160:163], v[48:51], v[112:115], v[160:163]
  v_mfma_f32_16x16x32_bf16 v[164:167], v[48:51], v[120:123], v[164:167]
  v_mfma_f32_16x16x32_bf16 v[168:171], v[48:51], v[128:131], v[168:171]
  v_mfma_f32_16x16x32_bf16 v[172:175], v[48:51], v[136:139], v[172:175]
  v_mfma_f32_16x16x32_bf16 v[144:147], v[52:55], v[84:87], v[144:147]
  v_mfma_f32_16x16x32_bf16 v[148:151], v[52:55], v[92:95], v[148:151]
  v_mfma_f32_16x16x32_bf16 v[152:155], v[52:55], v[100:103], v[152:155]
  v_mfma_f32_16x16x32_bf16 v[156:159], v[52:55], v[108:111], v[156:159]
  v_mfma_f32_16x16x32_bf16 v[160:163], v[52:55], v[116:119], v[160:163]
  v_mfma_f32_16x16x32_bf16 v[164:167], v[52:55], v[124:127], v[164:167]
  v_mfma_f32_16x16x32_bf16 v[168:171], v[52:55], v[132:135], v[168:171]
  v_mfma_f32_16x16x32_bf16 v[172:175], v[52:55], v[140:143], v[172:175]
  s_nop 7
  ds_read_b64_tr_b16 v[80:81], v12 offset:16384
  ds_read_b64_tr_b16 v[82:83], v12 offset:17408
  ds_read_b64_tr_b16 v[84:85], v12 offset:24576
  ds_read_b64_tr_b16 v[86:87], v12 offset:25600
  ds_read_b64_tr_b16 v[88:89], v12 offset:16416
  ds_read_b64_tr_b16 v[90:91], v12 offset:17440
  ds_read_b64_tr_b16 v[92:93], v12 offset:24608
  ds_read_b64_tr_b16 v[94:95], v12 offset:25632
  s_waitcnt lgkmcnt(0)
  ds_read_b64_tr_b16 v[96:97], v12 offset:16448
  ds_read_b64_tr_b16 v[98:99], v12 offset:17472
  ds_read_b64_tr_b16 v[100:101], v12 offset:24640
  ds_read_b64_tr_b16 v[102:103], v12 offset:25664
  ds_read_b64_tr_b16 v[104:105], v12 offset:16480
  ds_read_b64_tr_b16 v[106:107], v12 offset:17504
  ds_read_b64_tr_b16 v[108:109], v12 offset:24672
  ds_read_b64_tr_b16 v[110:111], v12 offset:25696
  s_waitcnt lgkmcnt(0)
  ds_read_b64_tr_b16 v[112:113], v12 offset:16512
  ds_read_b64_tr_b16 v[114:115], v12 offset:17536
  ds_read_b64_tr_b16 v[116:117], v12 offset:24704
  ds_read_b64_tr_b16 v[118:119], v12 offset:25728
  ds_read_b64_tr_b16 v[120:121], v12 offset:16544
  ds_read_b64_tr_b16 v[122:123], v12 offset:17568
  ds_read_b64_tr_b16 v[124:125], v12 offset:24736
  ds_read_b64_tr_b16 v[126:127], v12 offset:25760
  s_waitcnt lgkmcnt(0)
  ds_read_b64_tr_b16 v[128:129], v12 offset:16576
  ds_read_b64_tr_b16 v[130:131], v12 offset:17600
  ds_read_b64_tr_b16 v[132:133], v12 offset:24768
  ds_read_b64_tr_b16 v[134:135], v12 offset:25792
  ds_read_b64_tr_b16 v[136:137], v12 offset:16608
  ds_read_b64_tr_b16 v[138:139], v12 offset:17632
  ds_read_b64_tr_b16 v[140:141], v12 offset:24800
  ds_read_b64_tr_b16 v[142:143], v12 offset:25824
  s_waitcnt lgkmcnt(0)
  v_mfma_f32_16x16x32_bf16 v[144:147], v[56:59], v[80:83], v[144:147]
  v_mfma_f32_16x16x32_bf16 v[148:151], v[56:59], v[88:91], v[148:151]
  v_mfma_f32_16x16x32_bf16 v[152:155], v[56:59], v[96:99], v[152:155]
  v_mfma_f32_16x16x32_bf16 v[156:159], v[56:59], v[104:107], v[156:159]
  v_mfma_f32_16x16x32_bf16 v[160:163], v[56:59], v[112:115], v[160:163]
  v_mfma_f32_16x16x32_bf16 v[164:167], v[56:59], v[120:123], v[164:167]
  v_mfma_f32_16x16x32_bf16 v[168:171], v[56:59], v[128:131], v[168:171]
  v_mfma_f32_16x16x32_bf16 v[172:175], v[56:59], v[136:139], v[172:175]
  v_mfma_f32_16x16x32_bf16 v[144:147], v[60:63], v[84:87], v[144:147]
  v_mfma_f32_16x16x32_bf16 v[148:151], v[60:63], v[92:95], v[148:151]
  v_mfma_f32_16x16x32_bf16 v[152:155], v[60:63], v[100:103], v[152:155]
  v_mfma_f32_16x16x32_bf16 v[156:159], v[60:63], v[108:111], v[156:159]
  v_mfma_f32_16x16x32_bf16 v[160:163], v[60:63], v[116:119], v[160:163]
  v_mfma_f32_16x16x32_bf16 v[164:167], v[60:63], v[124:127], v[164:167]
  v_mfma_f32_16x16x32_bf16 v[168:171], v[60:63], v[132:135], v[168:171]
  v_mfma_f32_16x16x32_bf16 v[172:175], v[60:63], v[140:143], v[172:175]
  s_nop 1
  v_cndmask_b32 v32, v144, v148, s[72:73]
  v_cndmask_b32 v32, v32, v152, s[70:71]
  v_cndmask_b32 v32, v32, v156, s[24:25]
  v_cndmask_b32 v33, v145, v149, s[72:73]
  v_cndmask_b32 v33, v33, v153, s[70:71]
  v_cndmask_b32 v33, v33, v157, s[24:25]
  v_cndmask_b32 v34, v146, v150, s[72:73]
  v_cndmask_b32 v34, v34, v154, s[70:71]
  v_cndmask_b32 v34, v34, v158, s[24:25]
  v_cndmask_b32 v35, v147, v151, s[72:73]
  v_cndmask_b32 v35, v35, v155, s[70:71]
  v_cndmask_b32 v35, v35, v159, s[24:25]
  global_store_dwordx4 v13, v[32:35], s[26:27] offset:0 sc1 nt
  v_cndmask_b32 v36, v160, v164, s[72:73]
  v_cndmask_b32 v36, v36, v168, s[70:71]
  v_cndmask_b32 v36, v36, v172, s[24:25]
  v_cndmask_b32 v37, v161, v165, s[72:73]
  v_cndmask_b32 v37, v37, v169, s[70:71]
  v_cndmask_b32 v37, v37, v173, s[24:25]
  v_cndmask_b32 v38, v162, v166, s[72:73]
  v_cndmask_b32 v38, v38, v170, s[70:71]
  v_cndmask_b32 v38, v38, v174, s[24:25]
  v_cndmask_b32 v39, v163, v167, s[72:73]
  v_cndmask_b32 v39, v39, v171, s[70:71]
  v_cndmask_b32 v39, v39, v175, s[24:25]
  global_store_dwordx4 v13, v[36:39], s[26:27] offset:1024 sc1 nt
  s_lshl_b32 s64, s62, 9
  s_lshl_b32 s65, s61, 4
  s_add_u32 s64, s64, s65
  s_add_u32 s64, s64, 3424256
  v_mov_b32 v14, s64
  v_mov_b32 v40, 0
  v_mov_b32 v41, s30
  v_mov_b32 v42, 0
  v_mov_b32 v43, s31
  s_waitcnt vmcnt(0)
  s_mov_b64 exec, 1
  global_store_dwordx4 v14, v[40:43], s[26:27] sc1
  s_mov_b64 exec, -1
L_nof2:
  s_lshl_b32 s64, s100, 9
  s_add_u32 s64, s64, 3424256
  v_min_u32 v3, 11, v1
  v_lshl_add_u32 v15, v3, 4, s64
L_f3poll:
  global_load_dwordx4 v[44:47], v15, s[26:27] sc1
  s_waitcnt vmcnt(0)
  v_xor_b32 v64, s30, v45
  v_bitop3_b32 v64, v64, v47, s31 bitop3:0xf6
  v_cmp_ne_u32 vcc, 0, v64
  s_cbranch_vccz L_f3ok
  s_add_u32 s74, s74, 1
  s_cmp_gt_u32 s74, 100000
  s_cbranch_scc1 L_end
  s_sleep 120
  s_branch L_f3poll
L_f3ok:
  s_mul_i32 s64, s100, 24576
  s_lshl_b32 s65, s56, 6
  s_add_u32 s64, s64, s65
  s_add_u32 s64, s64, 3178496
  v_lshrrev_b32 v3, 2, v1
  v_lshlrev_b32 v3, 11, v3
  v_and_b32 v13, 3, v1
  v_lshl_add_u32 v3, v13, 4, v3
  v_add_u32 v14, s64, v3
  v_mov_b32 v48, 0
  v_mov_b32 v49, 0
  v_mov_b32 v50, 0
  v_mov_b32 v51, 0
  s_mov_b32 exec_hi, 0xffff
  global_load_dwordx4 v[48:51], v14, s[26:27] sc1 nt
  s_mov_b32 exec_hi, -1
  s_waitcnt vmcnt(0)
  v_add_f32 v48, v48, v48 row_ror:4 row_mask:0xf bank_mask:0xf
  v_add_f32 v49, v49, v49 row_ror:4 row_mask:0xf bank_mask:0xf
  v_add_f32 v50, v50, v50 row_ror:4 row_mask:0xf bank_mask:0xf
  v_add_f32 v51, v51, v51 row_ror:4 row_mask:0xf bank_mask:0xf
  v_add_f32 v48, v48, v48 row_ror:8 row_mask:0xf bank_mask:0xf
  v_add_f32 v49, v49, v49 row_ror:8 row_mask:0xf bank_mask:0xf
  v_add_f32 v50, v50, v50 row_ror:8 row_mask:0xf bank_mask:0xf
  v_add_f32 v51, v51, v51 row_ror:8 row_mask:0xf bank_mask:0xf
  v_mov_b32 v56, v48
  v_mov_b32 v57, v49
  v_mov_b32 v58, v50
  v_mov_b32 v59, v51
  v_permlane16_swap_b32 v48, v56
  v_permlane16_swap_b32 v49, v57
  v_permlane16_swap_b32 v50, v58
  v_permlane16_swap_b32 v51, v59
  v_add_f32 v48, v48, v56
  v_add_f32 v49, v49, v57
  v_add_f32 v50, v50, v58
  v_add_f32 v51, v51, v59
  v_mov_b32 v56, v48
  v_mov_b32 v57, v49
  v_mov_b32 v58, v50
  v_mov_b32 v59, v51
  v_permlane32_swap_b32 v48, v56
  v_permlane32_swap_b32 v49, v57
  v_permlane32_swap_b32 v50, v58
  v_permlane32_swap_b32 v51, v59
  v_add_f32 v48, v48, v56
  v_add_f32 v49, v49, v57
  v_add_f32 v50, v50, v58
  v_add_f32 v51, v51, v59
  v_cvt_pk_bf16_f32 v48, v48, v48
  v_lshlrev_b32 v48, 16, v48
  v_mul_f32 v56, 0xbfb8aa3b, v48
  v_cvt_pk_bf16_f32 v49, v49, v49
  v_lshlrev_b32 v49, 16, v49
  v_mul_f32 v57, 0xbfb8aa3b, v49
  v_cvt_pk_bf16_f32 v50, v50, v50
  v_lshlrev_b32 v50, 16, v50
  v_mul_f32 v58, 0xbfb8aa3b, v50
  v_cvt_pk_bf16_f32 v51, v51, v51
  v_lshlrev_b32 v51, 16, v51
  v_mul_f32 v59, 0xbfb8aa3b, v51
  v_exp_f32 v56, v56
  v_exp_f32 v57, v57
  v_exp_f32 v58, v58
  v_exp_f32 v59, v59
  v_add_f32 v56, 1.0, v56
  v_add_f32 v57, 1.0, v57
  v_add_f32 v58, 1.0, v58
  v_add_f32 v59, 1.0, v59
  v_rcp_f32 v56, v56
  v_rcp_f32 v57, v57
  v_rcp_f32 v58, v58
  v_rcp_f32 v59, v59
  v_mul_f32 v48, v48, v56
  v_mul_f32 v49, v49, v57
  v_mul_f32 v50, v50, v58
  v_mul_f32 v51, v51, v59
  v_cvt_pk_bf16_f32 v48, v48, v48
  v_lshlrev_b32 v48, 16, v48
  v_cvt_pk_bf16_f32 v49, v49, v49
  v_lshlrev_b32 v49, 16, v49
  v_cvt_pk_bf16_f32 v50, v50, v50
  v_lshlrev_b32 v50, 16, v50
  v_cvt_pk_bf16_f32 v51, v51, v51
  v_lshlrev_b32 v51, 16, v51
  v_lshlrev_b32 v3, 4, v13
  s_mov_b64 exec, 0xf
  ds_write_b128 v3, v[48:51] offset:7040
  s_mov_b64 exec, -1
  s_waitcnt lgkmcnt(0)
L_diag:
L_end:
  s_endpgm
.section .rodata,"a"
.p2align 6
.amdhsa_kernel recurrent_scan__mha_block_cached__geglu_ffn__decode_kernel
  .amdhsa_next_free_vgpr 256
  .amdhsa_next_free_sgpr 102
  .amdhsa_accum_offset 256
  .amdhsa_group_segment_fixed_size 0
  .amdhsa_kernarg_size 96
  .amdhsa_user_sgpr_count 2
  .amdhsa_user_sgpr_kernarg_segment_ptr 1
  .amdhsa_system_sgpr_workgroup_id_x 1
.end_amdhsa_kernel
```
